```python
import torch

def _softmax(x, axis=-1):
    return torch.softmax(x, dim=axis)
def _gelu(x):
    return torch.nn.functional.gelu(x, approximate="tanh")
def _silu(x):
    return torch.nn.functional.silu(x)
def _sigmoid(x):
    return torch.sigmoid(x)
def _layernorm(x, axis=-1, eps=1e-5):
    m = x.mean(dim=axis, keepdim=True)
    v = x.var(dim=axis, keepdim=True, unbiased=False)
    return (x - m) / torch.sqrt(v + eps)
def _scatter_add(tgt, idx, src, axis=0):
    return tgt.clone().index_add_(axis, idx, src)
def _segment_sum(src, seg, n):
    out = torch.zeros((n,) + src.shape[1:], dtype=src.dtype)
    return out.index_add_(0, seg, src)
def _pad(x, pw):
    flat = tuple(v for pair in reversed(pw) for v in pair)
    return torch.nn.functional.pad(x, flat)

kernel_name = 'sequential_preLN__sliding_block_cached__dense_activation_silu__decode'

def setup_inputs():

    _w = (lambda a: (lambda t: t.to(torch.bfloat16) if t.is_floating_point() else t)(torch.as_tensor(a)))
    def _A_setup():
        B, Sq, D = 1, 1, 640
        Hq, Hkv, Sk, Dh = 32, 32, 4096, 192
        assert Hq % Hkv == 0, (Hq, Hkv)
        return {
            "x": _w((lambda *s: torch.randn(*s, dtype=torch.bfloat16) * 0.05)(B, Sq, D)),
            "k_cache": _w((lambda *s: torch.randn(*s, dtype=torch.bfloat16) * 1.6)(B, Hkv, Sk, Dh)),
            "v_cache": _w((lambda *s: torch.randn(*s, dtype=torch.bfloat16) * 0.4)(B, Hkv, Sk, Dh)),
            "wq": _w((lambda *s: torch.randn(*s, dtype=torch.bfloat16) * 1.6)(D, Hq * Dh) * (D ** -0.5)),
            "wo": _w((lambda *s: torch.randn(*s, dtype=torch.bfloat16) * 0.4)(Hq * Dh, D) * ((Hq * Dh) ** -0.5)),
        }
    _A_in = _A_setup()

    def _B_setup():
        B, S, D, F = 1, 1, 640, 1536
        return {
            "x": _w((lambda *s: torch.randn(*s, dtype=torch.bfloat16) * 0.05)(B, S, D)),
            "w1": _w((lambda *s: torch.randn(*s, dtype=torch.bfloat16) * 0.8)(D, F) * (D ** -0.5)),
            "w2": _w((lambda *s: torch.randn(*s, dtype=torch.bfloat16) * 0.1)(F, D) * (F ** -0.5)),
        }
    _B_in = _B_setup()

    return {
        "A_x": _A_in["x"],
        "A_k_cache": _A_in["k_cache"],
        "A_v_cache": _A_in["v_cache"],
        "A_wq": _A_in["wq"],
        "A_wo": _A_in["wo"],
        "B_x": _B_in["x"],
        "B_w1": _B_in["w1"],
        "B_w2": _B_in["w2"],
    }

def reference(A_x, A_k_cache, A_v_cache, A_wq, A_wo, B_x, B_w1, B_w2):
    def _A_ref(x, k_cache, v_cache, wq, wo):
        B, Sq, D = x.shape
        Hq, Dh = 32, 192
        Hkv, Sk = k_cache.shape[1], k_cache.shape[2]
        W = min(4096, max(256, Sk // 4))
        rep = Hq // Hkv
        q = (lambda x, *d: x.permute(*d))((x @ wq).reshape(B, Sq, Hq, Dh), 0, 2, 1, 3)
        k = (lambda x, n, axis: torch.repeat_interleave(x, n, dim=axis))(k_cache[:, :, Sk - W:, :], rep, axis=1)
        v = (lambda x, n, axis: torch.repeat_interleave(x, n, dim=axis))(v_cache[:, :, Sk - W:, :], rep, axis=1)
        scores = torch.einsum("bhqd,bhkd->bhqk", q, k) * (Dh ** -0.5)
        p = _softmax(scores, axis=-1)
        o = torch.einsum("bhqk,bhkd->bhqd", p, v)
        return (lambda x, *d: x.permute(*d))(o, 0, 2, 1, 3).reshape(B, Sq, Hq * Dh) @ wo

    def _B_ref(x, w1, w2):
        h = torch.einsum("bsd,df->bsf", x, w1)
        h = _silu(h)
        out = torch.einsum("bsf,fd->bsd", h, w2)
        return out

    x = A_x
    h = x + _A_ref(_layernorm(x, axis=-1), A_k_cache, A_v_cache, A_wq, A_wo)
    h2 = h + _B_ref(_layernorm(h, axis=-1), B_w1, B_w2)
    return h2
```

```asm
; @launch grid=(256,1,1) block=(768,1,1) lds=93824
.amdgcn_target "amdgcn-amd-amdhsa--gfx950"
.text
.globl sequential_preLN__sliding_block_cached__dense_activation_silu__decode_kernel
.p2align 8
.type sequential_preLN__sliding_block_cached__dense_activation_silu__decode_kernel,@function
sequential_preLN__sliding_block_cached__dense_activation_silu__decode_kernel:
    s_cmp_ge_u32 s2, 256
    s_cbranch_scc1 L_end
    s_load_dwordx16 s[4:19], s[0:1], 0
    s_load_dwordx4 s[20:23], s[0:1], 64
    s_load_dwordx2 s[24:25], s[0:1], 80
    v_lshrrev_b32 v9, 6, v0
    v_and_b32 v1, 63, v0
    v_readfirstlane_b32 s3, v9
    v_lshrrev_b32 v2, 3, v1
    v_and_b32 v10, 7, v1
    v_lshlrev_b32 v3, 4, v10
    s_and_b32 s44, s2, 7
    s_lshr_b32 s101, s2, 3
    s_cmp_eq_u32 s44, 4
    s_cbranch_scc1 L_fxcd
    s_cmp_gt_u32 s44, 4
    s_subb_u32 s44, s44, 0
    s_and_b32 s26, s101, 3
    s_lshl2_add_u32 s26, s44, s26
    s_lshr_b32 s27, s101, 2
    s_cmp_ge_u32 s101, 28
    s_cselect_b32 s26, s101, s26
    s_cselect_b32 s27, s44, s27
    s_mul_i32 s28, s27, 11
    s_max_u32 s29, s27, 4
    s_add_u32 s28, s28, s29
    s_sub_u32 s28, s28, 4
    s_add_u32 s28, s28, s3
    s_mul_i32 s29, s28, 98304
    s_mul_i32 s30, s26, 384
    s_add_u32 s29, s29, s30
    v_mul_u32_u24 v11, 12288, v2
    v_add3_u32 v11, v11, v3, s29
    s_lshl_b32 s30, s28, 4
    v_lshl_add_u32 v12, v2, 1, s30
    v_lshlrev_b32 v13, 4, v1
    v_lshlrev_b32 v14, 2, v1
    s_mul_i32 s28, s27, 9
    s_add_u32 s28, s28, s3
    s_mul_i32 s29, s26, 0
    s_add_u32 s28, s28, s29
    s_and_b32 s28, s28, 63
    s_mul_i32 s29, s28, 6144
    s_mul_i32 s28, s26, 1572864
    s_add_u32 s28, s28, s29
    s_add_u32 s28, s28, 1179648
    v_mul_u32_u24 v15, 384, v2
    v_add3_u32 v15, v15, v3, s28
    s_cmp_ge_u32 s27, 4
    s_cselect_b32 s45, 12, 11
    s_waitcnt lgkmcnt(0)
    s_load_dword s34, s[24:25], 0
    s_cmp_lg_u32 s3, 0
    s_cbranch_scc1 L_nox
    global_load_dwordx4 v[16:19], v13, s[4:5]
    global_load_dword v20, v14, s[4:5] offset:1024
L_nox:
    s_cmp_ge_u32 s3, s45
    s_cbranch_scc1 L_noq
    global_load_ushort v21, v12, s[4:5]
    global_load_dwordx4 v[32:35], v11, s[10:11] offset:0 nt
    global_load_dwordx4 v[36:39], v11, s[10:11] offset:128 nt
    global_load_dwordx4 v[40:43], v11, s[10:11] offset:256 nt
    s_branch L_qiss
L_noq:
    v_mov_b32 v21, 0
    v_mov_b32 v32, 0
    v_mov_b32 v33, 0
    v_mov_b32 v34, 0
    v_mov_b32 v35, 0
    v_mov_b32 v36, 0
    v_mov_b32 v37, 0
    v_mov_b32 v38, 0
    v_mov_b32 v39, 0
    v_mov_b32 v40, 0
    v_mov_b32 v41, 0
    v_mov_b32 v42, 0
    v_mov_b32 v43, 0
L_qiss:
    v_lshrrev_b32 v9, 1, v10
    v_and_b32 v22, 1, v10
    v_mov_b32 v23, 0xffff
    v_lshlrev_b32 v22, 4, v22
    v_lshlrev_b32 v23, v22, v23
    v_cmp_eq_u32 vcc, 0, v9
    s_nop 1
    v_cndmask_b32 v4, 0, v23, vcc
    v_cmp_eq_u32 vcc, 1, v9
    s_nop 1
    v_cndmask_b32 v5, 0, v23, vcc
    v_cmp_eq_u32 vcc, 2, v9
    s_nop 1
    v_cndmask_b32 v6, 0, v23, vcc
    v_cmp_eq_u32 vcc, 3, v9
    s_nop 1
    v_cndmask_b32 v7, 0, v23, vcc
    s_mov_b32 s100, 4194304
    s_mov_b32 s36, 0x00ff00ff
    s_mov_b32 s37, 0xff00ff00
    s_mov_b32 s38, 0x00ff00ff
    s_mov_b32 s39, 0x00ff00ff
    s_mov_b32 s35, 1023
    v_lshrrev_b32 v9, 5, v1
    v_bfe_u32 v22, v1, 4, 1
    v_lshlrev_b32 v22, 4, v22
    v_lshl_add_u32 v22, v3, 1, v22
    s_mul_i32 s28, s3, 1792
    v_mul_u32_u24 v26, 896, v9
    v_add3_u32 v26, v26, v22, s28
    s_mul_i32 s28, s3, 768
    v_mul_u32_u24 v27, 384, v9
    v_add3_u32 v27, v27, v22, s28
    s_cmp_lt_u32 s101, 20
    s_cselect_b32 s15, 1, 0
    s_and_b32 s28, s101, 1
    s_lshr_b32 s48, s101, 1
    s_min_u32 s48, s48, 9
    s_lshl1_add_u32 s14, s44, s28
    s_cmp_ge_u32 s3, 6
    s_cselect_b32 s28, 1, 0
    s_cselect_b32 s29, 6, 0
    s_lshl1_add_u32 s46, s14, s28
    s_sub_u32 s47, s3, s29
    s_mul_i32 s28, s46, 6
    s_add_u32 s28, s28, s47
    s_mul_i32 s28, s28, 40960
    s_lshl_b32 s29, s48, 7
    s_add_u32 s28, s28, s29
    v_and_b32 v28, 1, v2
    v_lshlrev_b32 v28, 4, v28
    v_lshrrev_b32 v29, 1, v2
    v_add_u32 v28, v28, v29
    v_mul_u32_u24 v28, 1280, v28
    v_add3_u32 v28, v28, v3, s28
    s_barrier
    s_cmp_ge_u32 s3, 10
    s_cbranch_scc1 L_helper
    s_cmp_eq_u32 s27, 6
    s_cselect_b32 s28, 10, 9
    s_cmp_ge_u32 s3, s28
    s_cbranch_scc1 L_spare
    s_cmp_lg_u32 s3, 0
    s_cbranch_scc1 L_ln_1
    s_waitcnt vmcnt(3)
    v_lshlrev_b32 v120, 16, v16
    v_and_b32 v121, 0xffff0000, v16
    v_lshlrev_b32 v122, 16, v17
    v_and_b32 v123, 0xffff0000, v17
    v_lshlrev_b32 v124, 16, v18
    v_and_b32 v125, 0xffff0000, v18
    v_lshlrev_b32 v126, 16, v19
    v_and_b32 v127, 0xffff0000, v19
    v_lshlrev_b32 v128, 16, v20
    v_and_b32 v129, 0xffff0000, v20
    v_pk_add_f32 v[16:17], v[120:121], v[122:123]
    v_pk_add_f32 v[18:19], v[124:125], v[126:127]
    v_pk_add_f32 v[16:17], v[16:17], v[128:129]
    v_pk_add_f32 v[16:17], v[16:17], v[18:19]
    v_add_f32 v9, v16, v17
    s_nop 1
    v_add_f32_dpp v9, v9, v9 quad_perm:[1,0,3,2] row_mask:0xf bank_mask:0xf
    s_nop 1
    v_add_f32_dpp v9, v9, v9 quad_perm:[2,3,0,1] row_mask:0xf bank_mask:0xf
    s_nop 1
    v_add_f32_dpp v9, v9, v9 row_half_mirror row_mask:0xf bank_mask:0xf
    s_nop 1
    v_add_f32_dpp v9, v9, v9 row_ror:8 row_mask:0xf bank_mask:0xf
    v_mov_b32 v10, v9
    s_nop 1
    v_permlane16_swap_b32 v9, v10
    v_add_f32 v9, v9, v10
    v_mov_b32 v10, v9
    s_nop 1
    v_permlane32_swap_b32 v9, v10
    v_add_f32 v9, v9, v10
    v_mul_f32 v9, 0x3acccccd, v9
    v_sub_f32 v120, v120, v9
    v_sub_f32 v121, v121, v9
    v_sub_f32 v122, v122, v9
    v_sub_f32 v123, v123, v9
    v_sub_f32 v124, v124, v9
    v_sub_f32 v125, v125, v9
    v_sub_f32 v126, v126, v9
    v_sub_f32 v127, v127, v9
    v_sub_f32 v128, v128, v9
    v_sub_f32 v129, v129, v9
    v_mul_f32 v16, v120, v120
    v_mul_f32 v17, v121, v121
    v_fmac_f32 v16, v122, v122
    v_fmac_f32 v17, v123, v123
    v_fmac_f32 v16, v124, v124
    v_fmac_f32 v17, v125, v125
    v_fmac_f32 v16, v126, v126
    v_fmac_f32 v17, v127, v127
    v_fmac_f32 v16, v128, v128
    v_fmac_f32 v17, v129, v129
    v_add_f32 v16, v16, v17
    s_nop 1
    v_add_f32_dpp v16, v16, v16 quad_perm:[1,0,3,2] row_mask:0xf bank_mask:0xf
    s_nop 1
    v_add_f32_dpp v16, v16, v16 quad_perm:[2,3,0,1] row_mask:0xf bank_mask:0xf
    s_nop 1
    v_add_f32_dpp v16, v16, v16 row_half_mirror row_mask:0xf bank_mask:0xf
    s_nop 1
    v_add_f32_dpp v16, v16, v16 row_ror:8 row_mask:0xf bank_mask:0xf
    v_mov_b32 v10, v16
    s_nop 1
    v_permlane16_swap_b32 v16, v10
    v_add_f32 v16, v16, v10
    v_mov_b32 v10, v16
    s_nop 1
    v_permlane32_swap_b32 v16, v10
    v_add_f32 v16, v16, v10
    v_mul_f32 v16, 0x3acccccd, v16
    v_cvt_pk_bf16_f32 v9, v9, v9
    v_and_b32 v9, 0xffff0000, v9
    v_cvt_pk_bf16_f32 v16, v16, v16
    v_and_b32 v16, 0xffff0000, v16
    v_add_f32 v16, 0x3727c5ac, v16
    v_cvt_pk_bf16_f32 v16, v16, v16
    v_and_b32 v16, 0xffff0000, v16
    v_sqrt_f32 v16, v16
    s_nop 0
    v_cvt_pk_bf16_f32 v16, v16, v16
    v_and_b32 v16, 0xffff0000, v16
    v_rcp_f32 v17, v16
    v_mov_b32 v16, v9
    v_mov_b32 v10, 0
    ds_write_b64 v10, v[16:17] offset:22016
    s_waitcnt lgkmcnt(0)
L_ln_1:
    v_mov_b32 v10, 0
    s_barrier
    ds_read_b64 v[16:17], v10 offset:22016
    s_waitcnt vmcnt(3)
    v_lshlrev_b32 v21, 16, v21
    s_waitcnt lgkmcnt(0)
    v_sub_f32 v21, v21, v16
    v_cvt_pk_bf16_f32 v21, v21, v21
    v_and_b32 v21, 0xffff0000, v21
    v_mul_f32 v21, v21, v17
    v_cvt_pk_bf16_f32 v21, v21, v21
    v_and_b32 v22, v21, v4
    v_and_b32 v23, v21, v5
    v_and_b32 v24, v21, v6
    v_and_b32 v25, v21, v7
    s_add_u32 s33, s34, 1
    s_and_b32 s34, s33, s35
    v_mov_b32 v8, s34
    s_waitcnt vmcnt(2)
    global_load_dwordx4 v[44:47], v15, s[6:7] offset:0 nt
    v_mfma_f32_16x16x32_bf16 v[120:123], v[22:25], v[32:35], 0
    s_waitcnt vmcnt(2)
    global_load_dwordx4 v[48:51], v15, s[6:7] offset:128 nt
    v_mfma_f32_16x16x32_bf16 v[124:127], v[22:25], v[36:39], 0
    s_waitcnt vmcnt(2)
    global_load_dwordx4 v[52:55], v15, s[6:7] offset:256 nt
    v_mfma_f32_16x16x32_bf16 v[128:131], v[22:25], v[40:43], 0
    s_mov_b64 exec, s[36:37]
    s_nop 0
    ds_write_b128 v26, v[120:123] offset:0
    s_nop 1
    ds_write_b128 v26, v[124:127] offset:256
    s_nop 1
    ds_write_b128 v26, v[128:131] offset:512
    s_mov_b64 exec, -1
    s_waitcnt lgkmcnt(0)
    s_barrier
    v_mov_b32 v11, 0
    s_mov_b32 s43, 0
    s_cmp_eq_u32 s15, 0
    s_cbranch_scc1 L_strn
    s_waitcnt vmcnt(2)
    global_load_dwordx4 v[56:59], v15, s[6:7] offset:3072 nt
    s_waitcnt vmcnt(2)
    global_load_dwordx4 v[60:63], v15, s[6:7] offset:3200 nt
    s_waitcnt vmcnt(2)
    global_load_dwordx4 v[64:67], v15, s[6:7] offset:3328 nt
    s_waitcnt vmcnt(2)
    global_load_dwordx4 v[92:95], v28, s[12:13] nt
    v_add_u32 v28, 5120, v28
    v_mov_b32 v9, 6
    ds_write_b32 v11, v9 offset:22048
    s_waitcnt vmcnt(2)
    global_load_dwordx4 v[96:99], v28, s[12:13] nt
    v_add_u32 v28, 5120, v28
    ds_read_b32 v9, v11 offset:22052
    s_waitcnt lgkmcnt(0)
    v_readfirstlane_b32 s42, v9
    s_cmp_lg_u32 s42, 0
    s_cbranch_scc1 L_cu_2
    s_waitcnt vmcnt(2)
L_cu_2:
    s_waitcnt vmcnt(2)
    global_load_dwordx4 v[100:103], v28, s[12:13] nt
    v_add_u32 v28, 5120, v28
    s_cmp_eq_u32 s43, 1
    s_cbranch_scc1 L_qc_3
    ds_read_b32 v9, v11 offset:22040
    s_waitcnt lgkmcnt(0)
    v_readfirstlane_b32 s28, v9
    s_cmp_eq_u32 s28, 0
    s_cbranch_scc1 L_qc_3
    s_call_b64 s[50:51], L_score
L_qc_3:
    ds_read_b32 v9, v11 offset:22052
    s_waitcnt lgkmcnt(0)
    v_readfirstlane_b32 s42, v9
    s_cmp_lg_u32 s42, 0
    s_cbranch_scc1 L_cu_4
    s_waitcnt vmcnt(2)
L_cu_4:
    global_load_dwordx4 v[104:107], v28, s[12:13] nt
    s_cmp_eq_u32 s43, 1
    s_cbranch_scc1 L_qc_5
    ds_read_b32 v9, v11 offset:22040
    s_waitcnt lgkmcnt(0)
    v_readfirstlane_b32 s28, v9
    s_cmp_eq_u32 s28, 0
    s_cbranch_scc1 L_qc_5
    s_call_b64 s[50:51], L_score
L_qc_5:
    ds_read_b32 v9, v11 offset:22052
    s_waitcnt lgkmcnt(0)
    v_readfirstlane_b32 s42, v9
    s_cmp_lg_u32 s42, 0
    s_cbranch_scc1 L_cu_6
    s_waitcnt vmcnt(2)
L_cu_6:
    global_load_dwordx4 v[68:71], v15, s[8:9] offset:0 nt
    s_cmp_eq_u32 s43, 1
    s_cbranch_scc1 L_qc_7
    ds_read_b32 v9, v11 offset:22040
    s_waitcnt lgkmcnt(0)
    v_readfirstlane_b32 s28, v9
    s_cmp_eq_u32 s28, 0
    s_cbranch_scc1 L_qc_7
    s_call_b64 s[50:51], L_score
L_qc_7:
    ds_read_b32 v9, v11 offset:22052
    s_waitcnt lgkmcnt(0)
    v_readfirstlane_b32 s42, v9
    s_cmp_lg_u32 s42, 0
    s_cbranch_scc1 L_cu_8
    s_waitcnt vmcnt(2)
L_cu_8:
    global_load_dwordx4 v[72:75], v15, s[8:9] offset:128 nt
    s_cmp_eq_u32 s43, 1
    s_cbranch_scc1 L_qc_9
    ds_read_b32 v9, v11 offset:22040
    s_waitcnt lgkmcnt(0)
    v_readfirstlane_b32 s28, v9
    s_cmp_eq_u32 s28, 0
    s_cbranch_scc1 L_qc_9
    s_call_b64 s[50:51], L_score
L_qc_9:
    ds_read_b32 v9, v11 offset:22052
    s_waitcnt lgkmcnt(0)
    v_readfirstlane_b32 s42, v9
    s_cmp_lg_u32 s42, 0
    s_cbranch_scc1 L_cu_10
    s_waitcnt vmcnt(2)
L_cu_10:
    global_load_dwordx4 v[76:79], v15, s[8:9] offset:256 nt
    s_cmp_eq_u32 s43, 1
    s_cbranch_scc1 L_qc_11
    ds_read_b32 v9, v11 offset:22040
    s_waitcnt lgkmcnt(0)
    v_readfirstlane_b32 s28, v9
    s_cmp_eq_u32 s28, 0
    s_cbranch_scc1 L_qc_11
    s_call_b64 s[50:51], L_score
L_qc_11:
    ds_read_b32 v9, v11 offset:22052
    s_waitcnt lgkmcnt(0)
    v_readfirstlane_b32 s42, v9
    s_cmp_lg_u32 s42, 0
    s_cbranch_scc1 L_cu_12
    s_waitcnt vmcnt(2)
L_cu_12:
    global_load_dwordx4 v[80:83], v15, s[8:9] offset:3072 nt
    global_load_dwordx4 v[84:87], v15, s[8:9] offset:3200 nt
    global_load_dwordx4 v[88:91], v15, s[8:9] offset:3328 nt
    s_branch L_strj
L_strn:
    s_waitcnt vmcnt(2)
    global_load_dwordx4 v[56:59], v15, s[6:7] offset:3072 nt
    s_waitcnt vmcnt(2)
    global_load_dwordx4 v[60:63], v15, s[6:7] offset:3200 nt
    s_waitcnt vmcnt(2)
    global_load_dwordx4 v[64:67], v15, s[6:7] offset:3328 nt
    ds_read_b32 v9, v11 offset:22052
    s_waitcnt lgkmcnt(0)
    v_readfirstlane_b32 s42, v9
    s_cmp_lg_u32 s42, 0
    s_cbranch_scc1 L_cu_13
    s_waitcnt vmcnt(2)
L_cu_13:
    global_load_dwordx4 v[68:71], v15, s[8:9] offset:0 nt
    v_mov_b32 v9, 6
    ds_write_b32 v11, v9 offset:22048
    ds_read_b32 v9, v11 offset:22052
    s_waitcnt lgkmcnt(0)
    v_readfirstlane_b32 s42, v9
    s_cmp_lg_u32 s42, 0
    s_cbranch_scc1 L_cu_14
    s_waitcnt vmcnt(2)
L_cu_14:
    global_load_dwordx4 v[72:75], v15, s[8:9] offset:128 nt
    ds_read_b32 v9, v11 offset:22052
    s_waitcnt lgkmcnt(0)
    v_readfirstlane_b32 s42, v9
    s_cmp_lg_u32 s42, 0
    s_cbranch_scc1 L_cu_15
    s_waitcnt vmcnt(2)
L_cu_15:
    s_waitcnt vmcnt(2)
    global_load_dwordx4 v[76:79], v15, s[8:9] offset:256 nt
    s_cmp_eq_u32 s43, 1
    s_cbranch_scc1 L_qc_16
    ds_read_b32 v9, v11 offset:22040
    s_waitcnt lgkmcnt(0)
    v_readfirstlane_b32 s28, v9
    s_cmp_eq_u32 s28, 0
    s_cbranch_scc1 L_qc_16
    s_call_b64 s[50:51], L_score
L_qc_16:
    ds_read_b32 v9, v11 offset:22052
    s_waitcnt lgkmcnt(0)
    v_readfirstlane_b32 s42, v9
    s_cmp_lg_u32 s42, 0
    s_cbranch_scc1 L_cu_17
    s_waitcnt vmcnt(2)
L_cu_17:
    global_load_dwordx4 v[80:83], v15, s[8:9] offset:3072 nt
    s_cmp_eq_u32 s43, 1
    s_cbranch_scc1 L_qc_18
    ds_read_b32 v9, v11 offset:22040
    s_waitcnt lgkmcnt(0)
    v_readfirstlane_b32 s28, v9
    s_cmp_eq_u32 s28, 0
    s_cbranch_scc1 L_qc_18
    s_call_b64 s[50:51], L_score
L_qc_18:
    ds_read_b32 v9, v11 offset:22052
    s_waitcnt lgkmcnt(0)
    v_readfirstlane_b32 s42, v9
    s_cmp_lg_u32 s42, 0
    s_cbranch_scc1 L_cu_19
    s_waitcnt vmcnt(2)
L_cu_19:
    global_load_dwordx4 v[84:87], v15, s[8:9] offset:3200 nt
    s_cmp_eq_u32 s43, 1
    s_cbranch_scc1 L_qc_20
    ds_read_b32 v9, v11 offset:22040
    s_waitcnt lgkmcnt(0)
    v_readfirstlane_b32 s28, v9
    s_cmp_eq_u32 s28, 0
    s_cbranch_scc1 L_qc_20
    s_call_b64 s[50:51], L_score
L_qc_20:
    ds_read_b32 v9, v11 offset:22052
    s_waitcnt lgkmcnt(0)
    v_readfirstlane_b32 s42, v9
    s_cmp_lg_u32 s42, 0
    s_cbranch_scc1 L_cu_21
    s_waitcnt vmcnt(2)
L_cu_21:
    global_load_dwordx4 v[88:91], v15, s[8:9] offset:3328 nt
L_strj:
    v_mov_b32 v9, 1
    ds_write_b32 v11, v9 offset:22052
    s_lshl_b32 s28, s26, 3
    s_add_u32 s28, s28, s27
    s_lshl_b32 s28, s28, 10
    s_add_u32 s28, s28, 393216
    s_mov_b32 s30, 524288
    s_lshl_b32 s29, s26, 14
    s_add_u32 s30, s30, s29
    s_lshl_b32 s29, s27, 10
    s_add_u32 s30, s30, s29
    s_cmp_ge_u32 s101, 28
    s_cselect_b32 s28, s30, s28
    s_lshl_b32 s29, s3, 7
    v_mul_u32_u24 v29, 2688, v2
    v_add3_u32 v29, v29, v3, s29
    s_add_u32 s28, s28, s29
    v_lshrrev_b32 v25, 4, v1
    v_lshlrev_b32 v25, 2, v25
    v_add3_u32 v25, v25, v3, s28
    s_lshl_b32 s28, s46, 13
    s_add_u32 s28, s28, 393216
    v_min_u32 v13, 6, v2
    v_lshl_add_u32 v13, v13, 10, s28
    s_lshl_b32 s29, s47, 7
    v_add3_u32 v30, v13, v3, s29
    v_add_u32 v12, 768, v13
    s_lshl_b32 s29, s3, 7
    v_mul_u32_u24 v13, 1152, v2
    v_add3_u32 v13, v13, v3, s29
    s_lshr_b32 s28, s14, 1
    s_lshl_b32 s28, s28, 14
    s_and_b32 s30, s14, 1
    s_lshl_b32 s30, s30, 12
    s_add_u32 s28, s28, s30
    s_lshl_b32 s30, s48, 8
    s_add_u32 s28, s28, s30
    s_add_u32 s28, s28, s29
    s_mov_b32 s30, 655360
    s_add_u32 s28, s28, s30
    v_lshrrev_b32 v31, 4, v1
    v_lshlrev_b32 v31, 2, v31
    v_add3_u32 v31, v31, v3, s28
    s_mov_b32 s40, 0
    s_mov_b32 s41, 0xff000000
    s_waitcnt vmcnt(6)
L_qwait:
    s_cmp_eq_u32 s43, 1
    s_cbranch_scc1 L_qc_22
    ds_read_b32 v9, v11 offset:22040
    s_waitcnt lgkmcnt(0)
    v_readfirstlane_b32 s28, v9
    s_cmp_eq_u32 s28, 0
    s_cbranch_scc1 L_qc_22
    s_call_b64 s[50:51], L_score
L_qc_22:
    s_cmp_eq_u32 s43, 1
    s_cbranch_scc0 L_qwait_retry
L_qwait_ok:
    s_barrier
    ds_read_b128 v[120:123], v11 offset:21888
    ds_read_b128 v[124:127], v11 offset:21904
    ds_read_b128 v[128:131], v11 offset:21920
    ds_read_b32 v14, v11 offset:22032
    s_waitcnt lgkmcnt(0)
    v_max3_f32 v9, v120, v121, v122
    v_max3_f32 v18, v123, v124, v125
    v_max3_f32 v9, v9, v126, v127
    v_max3_f32 v18, v18, v128, v129
    v_max_f32 v9, v9, v18
    v_readfirstlane_b32 s49, v14
    v_sub_f32 v16, v16, v9
    v_sub_f32 v17, v17, v9
    v_mul_f32 v16, 0x3fb8aa3b, v16
    v_mul_f32 v17, 0x3fb8aa3b, v17
    v_exp_f32 v16, v16
    v_exp_f32 v17, v17
    s_nop 0
    v_add_f32 v9, v16, v17
    v_cvt_pk_bf16_f32 v16, v16, v16
    v_cvt_pk_bf16_f32 v17, v17, v17
    v_add_f32_dpp v9, v9, v9 row_ror:8 row_mask:0xf bank_mask:0xf
    v_mov_b32 v18, v9
    s_nop 1
    v_permlane16_swap_b32 v9, v18
    v_add_f32 v9, v9, v18
    v_mov_b32 v18, v9
    s_nop 1
    v_permlane32_swap_b32 v9, v18
    v_add_f32 v9, v9, v18
    ds_write_b32 v10, v9 offset:21952
    v_and_b32 v20, v16, v4
    v_and_b32 v21, v16, v5
    v_and_b32 v22, v16, v6
    v_and_b32 v23, v16, v7
    v_and_b32 v132, v17, v4
    v_and_b32 v133, v17, v5
    v_and_b32 v134, v17, v6
    v_and_b32 v135, v17, v7
    s_waitcnt lgkmcnt(0)
    s_barrier
    s_waitcnt vmcnt(5)
    v_mfma_f32_16x16x32_bf16 v[120:123], v[20:23], v[68:71], 0
    s_waitcnt vmcnt(4)
    v_mfma_f32_16x16x32_bf16 v[124:127], v[20:23], v[72:75], 0
    s_waitcnt vmcnt(3)
    v_mfma_f32_16x16x32_bf16 v[128:131], v[20:23], v[76:79], 0
    s_waitcnt vmcnt(2)
    v_mfma_f32_16x16x32_bf16 v[120:123], v[132:135], v[80:83], v[120:123]
    s_waitcnt vmcnt(1)
    v_mfma_f32_16x16x32_bf16 v[124:127], v[132:135], v[84:87], v[124:127]
    s_waitcnt vmcnt(0)
    global_load_dwordx4 v[48:51], v12, s[24:25] sc1
    s_setprio 3
    v_mfma_f32_16x16x32_bf16 v[128:131], v[132:135], v[88:91], v[128:131]
    s_mov_b64 exec, s[36:37]
    s_nop 0
    ds_write_b128 v26, v[120:123] offset:0
    s_nop 0
    ds_write_b128 v26, v[124:127] offset:256
    s_nop 2
    ds_write_b128 v26, v[128:131] offset:512
    s_mov_b64 exec, -1
    s_waitcnt lgkmcnt(0)
    s_barrier
    s_cmp_ge_u32 s3, 6
    s_cbranch_scc1 L_role0
    ds_read_b128 v[120:123], v29 offset:0
    ds_read_b128 v[124:127], v29 offset:896
    ds_read_b128 v[128:131], v29 offset:1792
    s_waitcnt lgkmcnt(0)
    v_pk_add_f32 v[120:121], v[120:121], v[124:125]
    v_pk_add_f32 v[122:123], v[122:123], v[126:127]
    v_pk_add_f32 v[120:121], v[120:121], v[128:129]
    v_pk_add_f32 v[122:123], v[122:123], v[130:131]
    s_nop 1
    v_permlane32_swap_b32 v120, v122
    v_permlane32_swap_b32 v121, v123
    v_pk_add_f32 v[120:121], v[120:121], v[122:123]
    s_nop 1
    v_permlane16_swap_b32 v120, v121
    v_add_f32 v120, v120, v121
    s_nop 1
    v_add_f32_dpp v120, v120, v120 row_ror:8 row_mask:0xf bank_mask:0xf
    s_mov_b64 exec, s[38:39]
    v_bfi_b32 v120, s35, v8, v120
    s_cmp_lg_u32 s49, 0
    s_cbranch_scc0 L_ds_23
    global_store_dword v25, v120, s[24:25]
L_ds_24:
    s_mov_b64 exec, -1
    s_branch L_role
L_spare:
    v_mov_b32 v10, 0
    s_barrier
    ds_read_b64 v[16:17], v10 offset:22016
    s_waitcnt vmcnt(3)
    v_lshlrev_b32 v21, 16, v21
    s_waitcnt lgkmcnt(0)
    v_sub_f32 v21, v21, v16
    v_cvt_pk_bf16_f32 v21, v21, v21
    v_and_b32 v21, 0xffff0000, v21
    v_mul_f32 v21, v21, v17
    v_cvt_pk_bf16_f32 v21, v21, v21
    v_and_b32 v22, v21, v4
    v_and_b32 v23, v21, v5
    v_and_b32 v24, v21, v6
    v_and_b32 v25, v21, v7
    s_add_u32 s33, s34, 1
    s_and_b32 s34, s33, s35
    v_mov_b32 v8, s34
    s_waitcnt vmcnt(2)
    v_mfma_f32_16x16x32_bf16 v[120:123], v[22:25], v[32:35], 0
    s_waitcnt vmcnt(1)
    v_mfma_f32_16x16x32_bf16 v[124:127], v[22:25], v[36:39], 0
    s_waitcnt vmcnt(0)
    v_mfma_f32_16x16x32_bf16 v[128:131], v[22:25], v[40:43], 0
    s_mov_b64 exec, s[36:37]
    s_nop 2
    ds_write_b128 v26, v[120:123] offset:0
    s_nop 0
    ds_write_b128 v26, v[124:127] offset:256
    s_nop 0
    ds_write_b128 v26, v[128:131] offset:512
    s_mov_b64 exec, -1
    s_waitcnt lgkmcnt(0)
    s_barrier
    s_branch L_hb3
L_helper:
    s_setprio 3
    s_lshl_b32 s28, s26, 3
    s_add_u32 s28, s28, s27
    s_lshl_b32 s28, s28, 10
    s_add_u32 s28, s28, 65536
    v_lshlrev_b32 v10, 3, v3
    s_cmp_eq_u32 s3, 11
    s_cselect_b32 s29, 327680, 0
    s_add_u32 s28, s28, s29
    v_add_u32 v10, s28, v10
    s_mov_b64 exec, 0x7f
    global_load_dword v160, v10, s[24:25] sc1
    s_mov_b64 exec, -1
    v_mov_b32 v10, 0
    s_barrier
    ds_read_b64 v[16:17], v10 offset:22016
    s_waitcnt vmcnt(4)
    v_lshlrev_b32 v21, 16, v21
    s_waitcnt lgkmcnt(0)
    v_sub_f32 v21, v21, v16
    v_cvt_pk_bf16_f32 v21, v21, v21
    v_and_b32 v21, 0xffff0000, v21
    v_mul_f32 v21, v21, v17
    v_cvt_pk_bf16_f32 v21, v21, v21
    v_and_b32 v22, v21, v4
    v_and_b32 v23, v21, v5
    v_and_b32 v24, v21, v6
    v_and_b32 v25, v21, v7
    s_add_u32 s33, s34, 1
    s_and_b32 s34, s33, s35
    v_mov_b32 v8, s34
    s_cmp_eq_u32 s3, 11
    s_cbranch_scc1 L_noxc
    s_getreg_b32 s21, hwreg(HW_REG_XCC_ID, 0, 4)
    s_lshl_b32 s21, s21, 10
    s_or_b32 s21, s21, s34
    s_lshl_b32 s28, s26, 3
    s_add_u32 s28, s28, s27
    s_lshl_b32 s28, s28, 10
    s_add_u32 s28, s28, 66304
    v_mov_b32 v10, s28
    v_mov_b32 v16, s21
    v_mov_b32 v17, s21
    s_mov_b64 exec, 1
    global_store_dwordx2 v10, v[16:17], s[24:25] sc1
    s_mov_b64 exec, -1
    s_waitcnt vmcnt(4)
    v_mfma_f32_16x16x32_bf16 v[120:123], v[22:25], v[32:35], 0
    s_waitcnt vmcnt(3)
    v_mfma_f32_16x16x32_bf16 v[124:127], v[22:25], v[36:39], 0
    s_waitcnt vmcnt(2)
    v_mfma_f32_16x16x32_bf16 v[128:131], v[22:25], v[40:43], 0
    s_branch L_xcd
L_noxc:
    s_waitcnt vmcnt(3)
    s_nop 1
    v_mfma_f32_16x16x32_bf16 v[120:123], v[22:25], v[32:35], 0
    s_waitcnt vmcnt(2)
    v_mfma_f32_16x16x32_bf16 v[124:127], v[22:25], v[36:39], 0
    s_waitcnt vmcnt(1)
    v_mfma_f32_16x16x32_bf16 v[128:131], v[22:25], v[40:43], 0
L_xcd:
    v_mov_b32 v9, 0
    ds_write_b32 v9, v9 offset:22040
    ds_write_b32 v9, v9 offset:22048
    ds_write_b32 v9, v9 offset:22052
    s_mov_b64 exec, s[36:37]
    ds_write_b128 v26, v[120:123] offset:0
    ds_write_b128 v26, v[124:127] offset:256
    s_nop 0
    ds_write_b128 v26, v[128:131] offset:512
    s_mov_b64 exec, -1
    s_waitcnt lgkmcnt(0)
    s_lshl_b32 s28, s26, 3
    s_add_u32 s28, s28, s27
    s_lshl_b32 s28, s28, 10
    s_add_u32 s28, s28, 65536
    s_sub_u32 s29, s3, 10
    s_lshl_b32 s29, s29, 9
    v_lshrrev_b32 v11, 4, v1
    v_and_b32 v10, 15, v1
    v_lshlrev_b32 v10, 4, v10
    v_mul_u32_u24 v9, 5376, v11
    v_add3_u32 v9, v9, v10, s29
    v_lshlrev_b32 v11, 2, v11
    s_add_u32 s28, s28, s29
    v_add3_u32 v10, v10, v11, s28
    s_cmp_ge_u32 s101, 28
    s_cselect_b32 s49, 0, 1
    s_barrier
    s_cmp_eq_u32 s3, 11
    s_cbranch_scc1 L_h11
    ds_read_b128 v[44:47], v9 offset:0
    ds_read_b128 v[48:51], v9 offset:896
    ds_read_b128 v[52:55], v9 offset:1792
    ds_read_b128 v[56:59], v9 offset:2688
    ds_read_b128 v[60:63], v9 offset:3584
    ds_read_b128 v[64:67], v9 offset:4480
    ds_read_b128 v[68:71], v9 offset:256
    ds_read_b128 v[72:75], v9 offset:1152
    ds_read_b128 v[76:79], v9 offset:2048
    ds_read_b128 v[80:83], v9 offset:2944
    ds_read_b128 v[84:87], v9 offset:3840
    ds_read_b128 v[88:91], v9 offset:4736
    s_waitcnt lgkmcnt(0)
    v_pk_add_f32 v[44:45], v[44:45], v[48:49]
    v_pk_add_f32 v[46:47], v[46:47], v[50:51]
    v_pk_add_f32 v[52:53], v[52:53], v[56:57]
    v_pk_add_f32 v[54:55], v[54:55], v[58:59]
    v_pk_add_f32 v[60:61], v[60:61], v[64:65]
    v_pk_add_f32 v[62:63], v[62:63], v[66:67]
    v_pk_add_f32 v[44:45], v[44:45], v[52:53]
    v_pk_add_f32 v[46:47], v[46:47], v[54:55]
    v_pk_add_f32 v[44:45], v[44:45], v[60:61]
    v_pk_add_f32 v[46:47], v[46:47], v[62:63]
    v_pk_add_f32 v[68:69], v[68:69], v[72:73]
    v_pk_add_f32 v[70:71], v[70:71], v[74:75]
    v_pk_add_f32 v[76:77], v[76:77], v[80:81]
    v_pk_add_f32 v[78:79], v[78:79], v[82:83]
    v_pk_add_f32 v[84:85], v[84:85], v[88:89]
    v_pk_add_f32 v[86:87], v[86:87], v[90:91]
    v_pk_add_f32 v[68:69], v[68:69], v[76:77]
    v_pk_add_f32 v[70:71], v[70:71], v[78:79]
    v_pk_add_f32 v[68:69], v[68:69], v[84:85]
    v_pk_add_f32 v[70:71], v[70:71], v[86:87]
    v_permlane32_swap_b32 v44, v46
    v_permlane32_swap_b32 v45, v47
    v_pk_add_f32 v[44:45], v[44:45], v[46:47]
    s_nop 1
    v_permlane16_swap_b32 v44, v45
    v_add_f32 v44, v44, v45
    v_permlane32_swap_b32 v68, v70
    v_permlane32_swap_b32 v69, v71
    v_pk_add_f32 v[68:69], v[68:69], v[70:71]
    s_nop 1
    v_permlane16_swap_b32 v68, v69
    v_add_f32 v68, v68, v69
    v_bfi_b32 v44, s35, v8, v44
    s_cmp_lg_u32 s49, 0
    s_cbranch_scc0 L_ds_25
    global_store_dword v10, v44, s[24:25] offset:0
L_ds_26:
    v_bfi_b32 v68, s35, v8, v68
    s_cmp_lg_u32 s49, 0
    s_cbranch_scc0 L_ds_27
    global_store_dword v10, v68, s[24:25] offset:256
L_ds_28:
    s_mov_b32 s32, 0
    s_cmp_ge_u32 s101, 28
    s_cbranch_scc1 L_selw
    s_lshl_b32 s28, s44, 15
    s_add_u32 s28, s28, 66304
    v_and_b32 v12, 3, v1
    v_lshlrev_b32 v12, 13, v12
    v_lshrrev_b32 v16, 2, v1
    v_lshlrev_b32 v16, 10, v16
    v_add3_u32 v12, v12, v16, s28
    v_mov_b32 v17, 0
L_ws_29:
    ds_read_b32 v16, v17 offset:22048
    s_waitcnt lgkmcnt(0)
    v_cmp_gt_u32 vcc, 6, v16
    s_cbranch_vccnz L_ws_29_retry
L_ws_29_ok:
    s_mov_b64 exec, 0xfffffff
L_xpoll:
    global_load_dwordx2 v[16:17], v12, s[24:25] sc1
    s_waitcnt vmcnt(0)
    v_xor_b32 v17, v16, v17
    v_xor_b32 v18, s34, v16
    v_and_or_b32 v17, v18, s35, v17
    v_cmp_ne_u32 vcc, 0, v17
    s_cbranch_vccnz L_xpoll_retry
L_xpoll_ok:
    v_cmp_ne_u32 vcc, s21, v16
    s_mov_b64 exec, -1
    s_cmp_eq_u32 vcc_lo, 0
    s_cselect_b32 s32, 1, 0
    s_cmp_lg_u32 s32, 0
    s_cbranch_scc1 L_selw
    global_store_dword v10, v44, s[24:25] offset:0 sc1
    global_store_dword v10, v68, s[24:25] offset:256 sc1
L_selw:
    v_mov_b32 v16, s32
    v_mov_b32 v9, 0
    ds_write_b32 v9, v16 offset:22032
    s_branch L_hb2
L_h11:
    ds_read_b128 v[92:95], v9 offset:0
    ds_read_b128 v[96:99], v9 offset:896
    ds_read_b128 v[100:103], v9 offset:1792
    ds_read_b128 v[104:107], v9 offset:2688
    ds_read_b128 v[108:111], v9 offset:3584
    ds_read_b128 v[112:115], v9 offset:4480
    s_waitcnt lgkmcnt(0)
    v_pk_add_f32 v[92:93], v[92:93], v[96:97]
    v_pk_add_f32 v[94:95], v[94:95], v[98:99]
    v_pk_add_f32 v[100:101], v[100:101], v[104:105]
    v_pk_add_f32 v[102:103], v[102:103], v[106:107]
    v_pk_add_f32 v[108:109], v[108:109], v[112:113]
    v_pk_add_f32 v[110:111], v[110:111], v[114:115]
    v_pk_add_f32 v[92:93], v[92:93], v[100:101]
    v_pk_add_f32 v[94:95], v[94:95], v[102:103]
    v_pk_add_f32 v[92:93], v[92:93], v[108:109]
    v_pk_add_f32 v[94:95], v[94:95], v[110:111]
    s_nop 1
    v_permlane32_swap_b32 v92, v94
    v_permlane32_swap_b32 v93, v95
    v_pk_add_f32 v[92:93], v[92:93], v[94:95]
    s_nop 1
    v_permlane16_swap_b32 v92, v93
    v_add_f32 v92, v92, v93
    v_bfi_b32 v92, s35, v8, v92
    s_cmp_lg_u32 s49, 0
    s_cbranch_scc0 L_ds_30
    global_store_dword v10, v92, s[24:25]
L_ds_31:
    v_mov_b32 v161, v92
    s_lshl_b32 s28, s26, 13
    s_add_u32 s28, s28, 65536
    v_add_u32 v9, s28, v13
    v_add_u32 v12, 4096, v9
    s_mov_b32 s20, 0
    v_mov_b32 v17, 0
L_ws_32:
    ds_read_b32 v16, v17 offset:22048
    s_waitcnt lgkmcnt(0)
    v_cmp_gt_u32 vcc, 6, v16
    s_cbranch_vccnz L_ws_32_retry
L_ws_32_ok:
    s_mov_b32 s28, -1
    s_mov_b32 s29, 0xffff
    s_mov_b64 exec, s[28:29]
    s_mov_b64 s[36:37], exec
    s_mov_b64 s[38:39], exec
    s_mov_b64 s[40:41], exec
    s_mov_b64 s[42:43], exec
    s_mov_b64 s[44:45], exec
    s_mov_b64 s[46:47], exec
    s_mov_b64 s[48:49], exec
    s_mov_b64 s[62:63], exec
L_qpoll:
    s_mov_b64 exec, s[36:37]
    global_load_dwordx4 v[44:47], v9, s[24:25] offset:0 sc1
    s_mov_b64 exec, s[38:39]
    global_load_dwordx4 v[48:51], v9, s[24:25] offset:1024 sc1
    s_mov_b64 exec, s[40:41]
    global_load_dwordx4 v[52:55], v9, s[24:25] offset:2048 sc1
    s_mov_b64 exec, s[42:43]
    global_load_dwordx4 v[56:59], v9, s[24:25] offset:3072 sc1
    s_mov_b64 exec, s[44:45]
    global_load_dwordx4 v[60:63], v12, s[24:25] offset:0 sc1
    s_mov_b64 exec, s[46:47]
    global_load_dwordx4 v[64:67], v12, s[24:25] offset:1024 sc1
    s_mov_b64 exec, s[48:49]
    global_load_dwordx4 v[68:71], v12, s[24:25] offset:2048 sc1
    s_mov_b32 s60, 0
    s_waitcnt vmcnt(0)
    s_mov_b64 exec, s[36:37]
    s_cbranch_execz L_sk_33
    v_xor_b32 v44, s34, v44
    v_xor_b32 v45, s34, v45
    v_xor_b32 v46, s34, v46
    v_xor_b32 v47, s34, v47
    v_or3_b32 v16, v44, v45, v46
    v_or_b32 v16, v16, v47
    v_and_b32 v16, s35, v16
    v_cmpx_ne_u32 vcc, 0, v16
    s_mov_b64 s[36:37], exec
    s_cbranch_execz L_sk_33
    s_bitset1_b32 s60, 0
L_sk_33:
    s_mov_b64 exec, s[38:39]
    s_cbranch_execz L_sk_34
    v_xor_b32 v48, s34, v48
    v_xor_b32 v49, s34, v49
    v_xor_b32 v50, s34, v50
    v_xor_b32 v51, s34, v51
    v_or3_b32 v16, v48, v49, v50
    v_or_b32 v16, v16, v51
    v_and_b32 v16, s35, v16
    v_cmpx_ne_u32 vcc, 0, v16
    s_mov_b64 s[38:39], exec
    s_cbranch_execz L_sk_34
    s_bitset1_b32 s60, 1
L_sk_34:
    s_mov_b64 exec, s[40:41]
    s_cbranch_execz L_sk_35
    v_xor_b32 v52, s34, v52
    v_xor_b32 v53, s34, v53
    v_xor_b32 v54, s34, v54
    v_xor_b32 v55, s34, v55
    v_or3_b32 v16, v52, v53, v54
    v_or_b32 v16, v16, v55
    v_and_b32 v16, s35, v16
    v_cmpx_ne_u32 vcc, 0, v16
    s_mov_b64 s[40:41], exec
    s_cbranch_execz L_sk_35
    s_bitset1_b32 s60, 2
L_sk_35:
    s_mov_b64 exec, s[42:43]
    s_cbranch_execz L_sk_36
    v_xor_b32 v56, s34, v56
    v_xor_b32 v57, s34, v57
    v_xor_b32 v58, s34, v58
    v_xor_b32 v59, s34, v59
    v_or3_b32 v16, v56, v57, v58
    v_or_b32 v16, v16, v59
    v_and_b32 v16, s35, v16
    v_cmpx_ne_u32 vcc, 0, v16
    s_mov_b64 s[42:43], exec
    s_cbranch_execz L_sk_36
    s_bitset1_b32 s60, 3
L_sk_36:
    s_mov_b64 exec, s[44:45]
    s_cbranch_execz L_sk_37
    v_xor_b32 v60, s34, v60
    v_xor_b32 v61, s34, v61
    v_xor_b32 v62, s34, v62
    v_xor_b32 v63, s34, v63
    v_or3_b32 v16, v60, v61, v62
    v_or_b32 v16, v16, v63
    v_and_b32 v16, s35, v16
    v_cmpx_ne_u32 vcc, 0, v16
    s_mov_b64 s[44:45], exec
    s_cbranch_execz L_sk_37
    s_bitset1_b32 s60, 4
L_sk_37:
    s_mov_b64 exec, s[46:47]
    s_cbranch_execz L_sk_38
    v_xor_b32 v64, s34, v64
    v_xor_b32 v65, s34, v65
    v_xor_b32 v66, s34, v66
    v_xor_b32 v67, s34, v67
    v_or3_b32 v16, v64, v65, v66
    v_or_b32 v16, v16, v67
    v_and_b32 v16, s35, v16
    v_cmpx_ne_u32 vcc, 0, v16
    s_mov_b64 s[46:47], exec
    s_cbranch_execz L_sk_38
    s_bitset1_b32 s60, 5
L_sk_38:
    s_mov_b64 exec, s[48:49]
    s_cbranch_execz L_sk_39
    v_xor_b32 v68, s34, v68
    v_xor_b32 v69, s34, v69
    v_xor_b32 v70, s34, v70
    v_xor_b32 v71, s34, v71
    v_or3_b32 v16, v68, v69, v70
    v_or_b32 v16, v16, v71
    v_and_b32 v16, s35, v16
    v_cmpx_ne_u32 vcc, 0, v16
    s_mov_b64 s[48:49], exec
    s_cbranch_execz L_sk_39
    s_bitset1_b32 s60, 6
L_sk_39:
    s_cmp_lg_u32 s60, 0
    s_cbranch_scc1 L_qpoll_more
L_qpoll_ok:
    s_mov_b64 exec, s[62:63]
    v_pk_add_f32 v[44:45], v[44:45], v[48:49]
    v_pk_add_f32 v[46:47], v[46:47], v[50:51]
    v_pk_add_f32 v[52:53], v[52:53], v[56:57]
    v_pk_add_f32 v[54:55], v[54:55], v[58:59]
    v_pk_add_f32 v[60:61], v[60:61], v[64:65]
    v_pk_add_f32 v[62:63], v[62:63], v[66:67]
    v_pk_add_f32 v[44:45], v[44:45], v[52:53]
    v_pk_add_f32 v[46:47], v[46:47], v[54:55]
    v_pk_add_f32 v[60:61], v[60:61], v[68:69]
    v_pk_add_f32 v[62:63], v[62:63], v[70:71]
    v_pk_add_f32 v[44:45], v[44:45], v[60:61]
    v_pk_add_f32 v[46:47], v[46:47], v[62:63]
    v_cvt_pk_bf16_f32 v16, v44, v45
    v_cvt_pk_bf16_f32 v17, v46, v47
    v_lshlrev_b32 v9, 3, v1
    ds_write_b64 v9, v[16:17] offset:21504
    v_mov_b32 v9, 0
    v_mov_b32 v16, 1
    ds_write_b32 v9, v16 offset:22040
    s_mov_b64 exec, -1
    s_mov_b32 s36, 0x00ff00ff
    s_mov_b32 s37, 0xff00ff00
    s_mov_b32 s38, 0x00ff00ff
    s_mov_b32 s39, 0x00ff00ff
    s_lshl1_add_u32 s46, s14, 1
    s_mov_b32 s47, 5
    s_lshr_b32 s48, s101, 1
L_hb2:
L_hb3:
    s_lshl_b32 s28, s3, 2
    v_mov_b32 v9, s28
    v_mov_b32 v16, 0xff800000
    v_mov_b32 v17, 0
    ds_write_b32 v9, v16 offset:21888
    ds_write_b32 v9, v17 offset:21952
    s_lshl_b32 s28, s46, 13
    s_add_u32 s28, s28, 393216
    v_min_u32 v13, 6, v2
    v_lshl_add_u32 v13, v13, 10, s28
    s_lshl_b32 s29, s47, 7
    v_add3_u32 v30, v13, v3, s29
    v_add_u32 v12, 768, v13
    s_lshl_b32 s29, s3, 7
    v_mul_u32_u24 v13, 1152, v2
    v_add3_u32 v13, v13, v3, s29
    s_lshr_b32 s28, s14, 1
    s_lshl_b32 s28, s28, 14
    s_and_b32 s30, s14, 1
    s_lshl_b32 s30, s30, 12
    s_add_u32 s28, s28, s30
    s_lshl_b32 s30, s48, 8
    s_add_u32 s28, s28, s30
    s_add_u32 s28, s28, s29
    s_mov_b32 s30, 655360
    s_add_u32 s28, s28, s30
    v_lshrrev_b32 v31, 4, v1
    v_lshlrev_b32 v31, 2, v31
    v_add3_u32 v31, v31, v3, s28
    s_mov_b32 s40, 0
    s_mov_b32 s41, 0xff000000
    s_waitcnt lgkmcnt(0)
    s_setprio 0
    s_barrier
    s_cmp_eq_u32 s15, 0
    s_cbranch_scc1 L_h_e
    global_load_dwordx4 v[92:95], v28, s[12:13] nt
    v_add_u32 v28, 5120, v28
    global_load_dwordx4 v[96:99], v28, s[12:13] nt
    v_add_u32 v28, 5120, v28
    global_load_dwordx4 v[100:103], v28, s[12:13] nt
    v_add_u32 v28, 5120, v28
    global_load_dwordx4 v[104:107], v28, s[12:13] nt
L_h_e:
    v_mov_b32 v11, 0
    ds_read_b32 v14, v11 offset:22032
    s_waitcnt lgkmcnt(0)
    v_readfirstlane_b32 s28, v14
    s_cmp_eq_u32 s3, 11
    s_cselect_b32 s28, s28, 1
    s_cmp_lg_u32 s28, 0
    s_cbranch_scc1 L_noqb
    global_store_dword v10, v161, s[24:25] sc1
L_noqb:
    v_mov_b32 v120, 0
    v_mov_b32 v121, 0
    v_mov_b32 v122, 0
    v_mov_b32 v123, 0
    v_mov_b32 v124, 0
    v_mov_b32 v125, 0
    v_mov_b32 v126, 0
    v_mov_b32 v127, 0
    v_mov_b32 v128, 0
    v_mov_b32 v129, 0
    v_mov_b32 v130, 0
    v_mov_b32 v131, 0
    s_mov_b64 exec, s[36:37]
    ds_write_b128 v26, v[120:123] offset:0
    ds_write_b128 v26, v[124:127] offset:256
    ds_write_b128 v26, v[128:131] offset:512
    s_mov_b64 exec, -1
    s_waitcnt lgkmcnt(0)
    s_lshl_b32 s28, s26, 3
    s_add_u32 s28, s28, s27
    s_lshl_b32 s28, s28, 10
    s_add_u32 s28, s28, 393984
    s_mov_b32 s30, 525056
    s_lshl_b32 s29, s26, 14
    s_add_u32 s30, s30, s29
    s_lshl_b32 s29, s27, 10
    s_add_u32 s30, s30, s29
    s_cmp_ge_u32 s101, 28
    s_cselect_b32 s28, s30, s28
    v_mov_b32 v10, s28
    v_mov_b32 v9, 0
    v_readfirstlane_b32 s49, v14
    s_barrier
    s_cmp_lg_u32 s3, 11
    s_cbranch_scc1 L_hb4
    ds_read_b128 v[120:123], v9 offset:21888
    ds_read_b128 v[124:127], v9 offset:21904
    ds_read_b128 v[128:131], v9 offset:21920
    ds_read_b128 v[68:71], v9 offset:21952
    ds_read_b128 v[72:75], v9 offset:21968
    ds_read_b128 v[76:79], v9 offset:21984
    s_waitcnt lgkmcnt(0)
    v_max3_f32 v16, v120, v121, v122
    v_max3_f32 v17, v123, v124, v125
    v_max3_f32 v16, v16, v126, v127
    v_max3_f32 v17, v17, v128, v129
    v_max_f32 v16, v16, v17
    v_pk_add_f32 v[68:69], v[68:69], v[72:73]
    v_pk_add_f32 v[70:71], v[70:71], v[74:75]
    v_pk_add_f32 v[68:69], v[68:69], v[76:77]
    v_pk_add_f32 v[70:71], v[70:71], v[78:79]
    v_pk_add_f32 v[68:69], v[68:69], v[70:71]
    v_add_f32 v17, v68, v69
    s_mov_b64 exec, 1
    v_bfi_b32 v16, s35, v8, v16
    v_bfi_b32 v17, s35, v8, v17
    v_mov_b32 v18, v16
    v_mov_b32 v19, v17
    s_cmp_lg_u32 s49, 0
    s_cbranch_scc0 L_ds_40
    global_store_dwordx4 v10, v[16:19], s[24:25]
L_ds_41:
    s_mov_b64 exec, -1
L_hb4:
    s_barrier
    s_branch L_roleh
L_role0:
    s_waitcnt vmcnt(0)
L_role:
    s_cmp_eq_u32 s15, 0
    s_cbranch_scc1 L_fin
    s_setprio 0
    global_load_dwordx4 v[44:47], v30, s[24:25] sc1
    s_mov_b64 s[52:53], -1
    s_waitcnt vmcnt(2)
    v_xor_b32 v48, s34, v48
    v_xor_b32 v49, s34, v49
    v_xor_b32 v50, s34, v50
    v_xor_b32 v51, s34, v51
    v_or3_b32 v16, v48, v49, v50
    v_or_b32 v16, v16, v51
    v_and_b32 v16, s35, v16
    v_cmpx_ne_u32 vcc, 0, v16
    s_cbranch_execz L_op_w
    s_mov_b64 s[54:55], exec
    global_load_dwordx4 v[48:51], v12, s[24:25] sc1
    s_branch L_op_a
L_roleh:
    s_cmp_eq_u32 s15, 0
    s_cbranch_scc1 L_fin
L_op_g:
    s_mov_b64 s[52:53], -1
    s_mov_b64 s[54:55], -1
    global_load_dwordx4 v[48:51], v12, s[24:25] sc1
    global_load_dwordx4 v[44:47], v30, s[24:25] sc1
L_op_a:
    s_waitcnt vmcnt(0)
    s_mov_b64 exec, s[52:53]
    v_xor_b32 v44, s34, v44
    v_xor_b32 v45, s34, v45
    v_xor_b32 v46, s34, v46
    v_xor_b32 v47, s34, v47
    v_or3_b32 v16, v44, v45, v46
    v_or_b32 v16, v16, v47
    v_and_b32 v16, s35, v16
    v_cmpx_ne_u32 vcc, 0, v16
    s_mov_b64 s[52:53], exec
    global_load_dwordx4 v[44:47], v30, s[24:25] sc1
    s_mov_b64 exec, s[54:55]
    v_xor_b32 v48, s34, v48
    v_xor_b32 v49, s34, v49
    v_xor_b32 v50, s34, v50
    v_xor_b32 v51, s34, v51
    v_or3_b32 v16, v48, v49, v50
    v_or_b32 v16, v16, v51
    v_and_b32 v16, s35, v16
    v_cmpx_ne_u32 vcc, 0, v16
    s_cbranch_execnz L_op_s
L_op_w:
    s_mov_b64 exec, -1
    v_mov_b32 v16, v48
    s_nop 1
    v_max_f32_dpp v16, v16, v16 row_ror:8 row_mask:0xf bank_mask:0xf
    v_mov_b32 v17, v16
    s_nop 1
    v_permlane16_swap_b32 v16, v17
    v_max_f32 v16, v16, v17
    v_mov_b32 v17, v16
    s_nop 1
    v_permlane32_swap_b32 v16, v17
    v_max_f32 v16, v16, v17
    v_sub_f32 v16, v48, v16
    v_mul_f32 v16, 0x3fb8aa3b, v16
    v_exp_f32 v18, v16
    s_nop 0
    v_cndmask_b32 v18, v18, 0, s[40:41]
    v_mul_f32 v24, v18, v49
    s_nop 1
    v_add_f32_dpp v24, v24, v24 row_ror:8 row_mask:0xf bank_mask:0xf
    v_mov_b32 v17, v24
    s_nop 1
    v_permlane16_swap_b32 v24, v17
    v_add_f32 v24, v24, v17
    v_mov_b32 v17, v24
    s_nop 1
    v_permlane32_swap_b32 v24, v17
    v_add_f32 v24, v24, v17
    v_rcp_f32 v24, v24
    s_nop 0
    v_mul_f32 v18, v18, v24
    s_mov_b64 exec, s[52:53]
    s_cbranch_execnz L_op_in
    s_branch L_op_out
L_op:
    global_load_dwordx4 v[44:47], v30, s[24:25] sc1
    s_sub_u32 s100, s100, 1
    s_cbranch_scc1 L_op_out
L_op_in:
    s_waitcnt vmcnt(0)
    v_xor_b32 v44, s34, v44
    v_xor_b32 v45, s34, v45
    v_xor_b32 v46, s34, v46
    v_xor_b32 v47, s34, v47
    v_or3_b32 v16, v44, v45, v46
    v_or_b32 v16, v16, v47
    v_and_b32 v16, s35, v16
    v_cmpx_ne_u32 vcc, 0, v16
    s_cbranch_execnz L_op
L_op_out:
    s_mov_b64 exec, -1
    s_setprio 3
    v_pk_mul_f32 v[44:45], v[44:45], v[18:19] op_sel_hi:[1,0]
    v_pk_mul_f32 v[46:47], v[46:47], v[18:19] op_sel_hi:[1,0]
    s_nop 1
    v_permlane32_swap_b32 v44, v46
    v_permlane32_swap_b32 v45, v47
    v_pk_add_f32 v[44:45], v[44:45], v[46:47]
    s_nop 1
    v_permlane16_swap_b32 v44, v45
    v_add_f32 v44, v44, v45
    s_nop 1
    v_add_f32_dpp v44, v44, v44 row_ror:8 row_mask:0xf bank_mask:0xf
    v_cvt_pk_bf16_f32 v16, v44, v44
    s_nop 1
    v_mov_b32_dpp v16, v16 row_shr:4 row_mask:0xf bank_mask:0x2
    s_nop 1
    v_mov_b32_dpp v16, v16 row_shl:4 row_mask:0xf bank_mask:0x4
    s_nop 1
    v_mov_b32_dpp v20, v16 quad_perm:[0,0,0,0] row_mask:0xf bank_mask:0xf
    v_and_b32 v68, v20, v4
    v_and_b32 v69, v20, v5
    v_and_b32 v70, v20, v6
    v_and_b32 v71, v20, v7
    v_mov_b32_dpp v21, v16 quad_perm:[1,1,1,1] row_mask:0xf bank_mask:0xf
    v_and_b32 v72, v21, v4
    v_and_b32 v73, v21, v5
    v_and_b32 v74, v21, v6
    v_and_b32 v75, v21, v7
    v_mfma_f32_16x16x32_bf16 v[120:123], v[68:71], v[92:95], 0
    v_mov_b32_dpp v22, v16 quad_perm:[2,2,2,2] row_mask:0xf bank_mask:0xf
    v_and_b32 v76, v22, v4
    v_and_b32 v77, v22, v5
    v_and_b32 v78, v22, v6
    v_and_b32 v79, v22, v7
    v_mfma_f32_16x16x32_bf16 v[120:123], v[72:75], v[96:99], v[120:123]
    v_mov_b32_dpp v23, v16 quad_perm:[3,3,3,3] row_mask:0xf bank_mask:0xf
    v_and_b32 v80, v23, v4
    v_and_b32 v81, v23, v5
    v_and_b32 v82, v23, v6
    v_and_b32 v83, v23, v7
    v_mfma_f32_16x16x32_bf16 v[120:123], v[76:79], v[100:103], v[120:123]
    s_nop 0
    v_mfma_f32_16x16x32_bf16 v[120:123], v[80:83], v[104:107], v[120:123]
    s_mov_b64 exec, s[36:37]
    s_nop 6
    ds_write_b128 v27, v[120:123] offset:22144
    s_mov_b64 exec, -1
    s_waitcnt lgkmcnt(0)
    s_barrier
    s_cmp_ge_u32 s3, 2
    s_cbranch_scc1 L_fin
    v_add_u32 v19, 8192, v31
    ds_read_b128 v[120:123], v13 offset:22144
    ds_read_b128 v[124:127], v13 offset:22528
    ds_read_b128 v[128:131], v13 offset:22912
    s_waitcnt lgkmcnt(0)
    v_pk_add_f32 v[120:121], v[120:121], v[124:125]
    v_pk_add_f32 v[122:123], v[122:123], v[126:127]
    v_pk_add_f32 v[120:121], v[120:121], v[128:129]
    v_pk_add_f32 v[122:123], v[122:123], v[130:131]
    s_nop 1
    v_permlane32_swap_b32 v120, v122
    v_permlane32_swap_b32 v121, v123
    v_pk_add_f32 v[120:121], v[120:121], v[122:123]
    s_nop 1
    v_permlane16_swap_b32 v120, v121
    v_add_f32 v120, v120, v121
    s_nop 1
    v_add_f32_dpp v120, v120, v120 row_ror:8 row_mask:0xf bank_mask:0xf
    s_mov_b64 exec, s[38:39]
    v_bfi_b32 v120, s35, v8, v120
    global_store_dword v31, v120, s[24:25] sc1
    global_store_dword v19, v120, s[24:25] sc1
    s_mov_b64 exec, -1
    s_branch L_fin
L_fxcd:
    s_mul_i32 s28, s3, 491520
    s_lshl_b32 s29, s101, 7
    s_add_u32 s28, s28, s29
    v_mul_u32_u24 v28, 3072, v2
    v_add3_u32 v28, v28, v3, s28
    s_mul_i32 s28, s101, 81920
    s_sub_u32 s29, s3, 4
    s_mul_i32 s29, s29, 10240
    s_add_u32 s28, s28, s29
    v_mul_u32_u24 v29, 1280, v2
    v_add3_u32 v29, v29, v3, s28
    s_waitcnt lgkmcnt(0)
    s_load_dword s34, s[24:25], 0
    s_mov_b32 s100, 4194304
    s_mov_b32 s35, 1023
    s_waitcnt lgkmcnt(0)
    s_barrier
    s_cmp_ge_u32 s101, 24
    s_cbranch_scc1 L_redu
    s_cmp_ge_u32 s3, 4
    s_cbranch_scc1 L_fw2
    global_load_dwordx4 v[32:35], v28, s[16:17] nt
    v_add_u32 v28, 24576, v28
    global_load_dwordx4 v[36:39], v28, s[16:17] nt
    v_add_u32 v28, 24576, v28
    global_load_dwordx4 v[40:43], v28, s[16:17] nt
    v_add_u32 v28, 24576, v28
    global_load_dwordx4 v[44:47], v28, s[16:17] nt
    v_add_u32 v28, 24576, v28
    s_waitcnt vmcnt(3)
    global_load_dwordx4 v[48:51], v28, s[16:17] nt
    v_add_u32 v28, 24576, v28
    s_waitcnt vmcnt(3)
    global_load_dwordx4 v[52:55], v28, s[16:17] nt
    v_add_u32 v28, 24576, v28
    s_waitcnt vmcnt(3)
    global_load_dwordx4 v[56:59], v28, s[16:17] nt
    v_add_u32 v28, 24576, v28
    s_waitcnt vmcnt(3)
    global_load_dwordx4 v[60:63], v28, s[16:17] nt
    v_add_u32 v28, 24576, v28
    s_waitcnt vmcnt(3)
    global_load_dwordx4 v[96:99], v28, s[16:17] nt
    v_add_u32 v28, 24576, v28
    s_waitcnt vmcnt(3)
    global_load_dwordx4 v[100:103], v28, s[16:17] nt
    v_add_u32 v28, 24576, v28
    s_waitcnt vmcnt(3)
    global_load_dwordx4 v[104:107], v28, s[16:17] nt
    v_add_u32 v28, 24576, v28
    s_waitcnt vmcnt(3)
    global_load_dwordx4 v[108:111], v28, s[16:17] nt
    v_add_u32 v28, 24576, v28
    s_waitcnt vmcnt(7)
    global_load_dwordx4 v[112:115], v28, s[16:17] nt
    v_add_u32 v28, 24576, v28
    s_waitcnt vmcnt(7)
    global_load_dwordx4 v[116:119], v28, s[16:17] nt
    v_add_u32 v28, 24576, v28
    s_waitcnt vmcnt(7)
    global_load_dwordx4 v[120:123], v28, s[16:17] nt
    v_add_u32 v28, 24576, v28
    s_waitcnt vmcnt(7)
    global_load_dwordx4 v[124:127], v28, s[16:17] nt
    v_add_u32 v28, 24576, v28
    s_waitcnt vmcnt(7)
    global_load_dwordx4 v[128:131], v28, s[16:17] nt
    v_add_u32 v28, 24576, v28
    s_waitcnt vmcnt(7)
    global_load_dwordx4 v[132:135], v28, s[16:17] nt
    v_add_u32 v28, 24576, v28
    s_waitcnt vmcnt(7)
    global_load_dwordx4 v[136:139], v28, s[16:17] nt
    v_add_u32 v28, 24576, v28
    s_waitcnt vmcnt(7)
    global_load_dwordx4 v[140:143], v28, s[16:17] nt
    v_add_u32 v28, 24576, v28
    s_branch L_fsetup
L_fw2:
    s_cmp_lg_u32 s3, 10
    s_cbranch_scc1 L_fw2b
    s_setprio 3
    s_call_b64 s[50:51], L_meas
    s_call_b64 s[50:51], L_fxcc
    s_setprio 0
L_fw2b:
    v_mov_b32 v28, v29
    s_cmp_lg_u32 s3, 11
    s_cbranch_scc1 L_fsetup
    s_mul_i32 s28, s101, 2560
    s_add_u32 s28, s28, 786432
    v_lshlrev_b32 v9, 7, v1
    v_add_u32 v9, s28, v9
    s_mov_b64 exec, 0xfffff
    global_load_dword v20, v9, s[24:25] sc1
    s_mov_b64 exec, -1
L_fsetup:
    s_mul_i32 s28, s3, 23040
    v_mul_u32_u24 v11, 144, v2
    v_add3_u32 v11, v11, v3, s28
    s_sub_u32 s28, s3, 4
    s_mul_i32 s28, s28, 10368
    v_mul_u32_u24 v29, 1296, v2
    v_add3_u32 v29, v29, v3, s28
    v_lshrrev_b32 v9, 4, v1
    v_and_b32 v10, 15, v1
    v_lshrrev_b32 v13, 1, v9
    v_lshlrev_b32 v13, 14, v13
    v_and_b32 v27, 1, v9
    v_lshl_add_u32 v13, v27, 12, v13
    v_lshlrev_b32 v27, 4, v10
    s_mov_b32 s29, 655360
    s_lshl_b32 s28, s3, 8
    s_add_u32 s28, s28, s29
    v_add3_u32 v13, v13, v27, s28
    v_add_u32 v14, 32768, v13
    v_add_u32 v15, 65536, v13
    v_add_u32 v25, 98304, v13
    s_min_u32 s28, s3, 9
    s_lshl_b32 s28, s28, 7
    v_lshlrev_b32 v27, 3, v10
    v_lshl_add_u32 v27, v9, 1, v27
    v_add_u32 v27, s28, v27
    v_mov_b32 v24, 0
    global_load_short_d16_hi v24, v27, s[4:5]
    s_and_b32 s45, s3, 3
    s_mul_i32 s28, s101, 2560
    s_mul_i32 s29, s45, 640
    s_add_u32 s28, s28, s29
    s_add_u32 s28, s28, 786432
    v_lshlrev_b32 v30, 2, v1
    v_add_u32 v30, s28, v30
    v_lshrrev_b32 v26, 2, v10
    v_lshl_add_u32 v22, v9, 3, v26
    v_and_b32 v23, 3, v1
    v_lshlrev_b32 v23, 3, v23
    v_lshlrev_b32 v31, 4, v9
    s_waitcnt lgkmcnt(0)
    s_cmp_eq_u32 s3, 10
    s_cbranch_scc1 L_ftag
    s_add_u32 s33, s34, 1
    s_and_b32 s34, s33, s35
    v_mov_b32 v8, s34
L_ftag:
    v_cmp_eq_u32 vcc, 0, v26
    v_mov_b32 v4, 93568
    v_add_u32 v9, 93440, v31
    v_cndmask_b32 v4, v4, v9, vcc
    v_cmp_eq_u32 vcc, 1, v26
    v_mov_b32 v5, 93568
    v_add_u32 v9, 93440, v31
    v_cndmask_b32 v5, v5, v9, vcc
    v_cmp_eq_u32 vcc, 2, v26
    v_mov_b32 v6, 93568
    v_add_u32 v9, 93440, v31
    v_cndmask_b32 v6, v6, v9, vcc
    v_cmp_eq_u32 vcc, 3, v26
    v_mov_b32 v7, 93568
    v_add_u32 v9, 93440, v31
    v_cndmask_b32 v7, v7, v9, vcc
    v_add_u32 v31, 92160, v31
    v_add_u32 v27, 92160, v27
    v_mov_b32 v16, 0
    v_lshlrev_b32 v9, 2, v1
    v_add_u32 v9, 93568, v9
    s_mov_b64 exec, 0xffffffff
    ds_write_b32 v9, v16
    s_mov_b64 exec, -1
    s_cmp_ge_u32 s3, 4
    s_cbranch_scc1 L_ft0
    s_waitcnt vmcnt(20)
    ds_write_b128 v11, v[32:35] offset:0
    s_waitcnt vmcnt(19)
    ds_write_b128 v11, v[36:39] offset:1152
    s_waitcnt vmcnt(18)
    ds_write_b128 v11, v[40:43] offset:2304
    s_waitcnt vmcnt(17)
    ds_write_b128 v11, v[44:47] offset:3456
    s_waitcnt vmcnt(16)
    ds_write_b128 v11, v[48:51] offset:4608
    s_waitcnt vmcnt(15)
    ds_write_b128 v11, v[52:55] offset:5760
    s_waitcnt vmcnt(14)
    ds_write_b128 v11, v[56:59] offset:6912
    s_waitcnt vmcnt(13)
    ds_write_b128 v11, v[60:63] offset:8064
    s_waitcnt vmcnt(12)
    ds_write_b128 v11, v[96:99] offset:9216
    s_waitcnt vmcnt(11)
    ds_write_b128 v11, v[100:103] offset:10368
    s_waitcnt vmcnt(10)
    ds_write_b128 v11, v[104:107] offset:11520
    s_waitcnt vmcnt(9)
    ds_write_b128 v11, v[108:111] offset:12672
    s_waitcnt vmcnt(8)
    ds_write_b128 v11, v[112:115] offset:13824
    s_waitcnt vmcnt(7)
    ds_write_b128 v11, v[116:119] offset:14976
    s_waitcnt vmcnt(6)
    ds_write_b128 v11, v[120:123] offset:16128
    s_waitcnt vmcnt(5)
    ds_write_b128 v11, v[124:127] offset:17280
    s_waitcnt vmcnt(4)
    ds_write_b128 v11, v[128:131] offset:18432
    s_waitcnt vmcnt(3)
    ds_write_b128 v11, v[132:135] offset:19584
    s_waitcnt vmcnt(2)
    ds_write_b128 v11, v[136:139] offset:20736
    s_waitcnt vmcnt(1)
    ds_write_b128 v11, v[140:143] offset:21888
L_ft0:
    s_waitcnt lgkmcnt(0)
    s_barrier
    s_cmp_ge_u32 s3, 4
    s_cbranch_scc1 L_ft2
    s_lshl_b32 s28, s45, 5
    v_mul_u32_u24 v9, 144, v22
    v_add3_u32 v9, v9, v23, s28
    v_add_u32 v16, 46080, v9
    ds_read_b64_tr_b16 v[32:33], v9 offset:0
    ds_read_b64_tr_b16 v[34:35], v9 offset:576
    ds_read_b64_tr_b16 v[36:37], v9 offset:4608
    ds_read_b64_tr_b16 v[38:39], v9 offset:5184
    ds_read_b64_tr_b16 v[40:41], v9 offset:9216
    ds_read_b64_tr_b16 v[42:43], v9 offset:9792
    ds_read_b64_tr_b16 v[44:45], v9 offset:13824
    ds_read_b64_tr_b16 v[46:47], v9 offset:14400
    s_waitcnt lgkmcnt(0)
    ds_read_b64_tr_b16 v[48:49], v9 offset:18432
    ds_read_b64_tr_b16 v[50:51], v9 offset:19008
    ds_read_b64_tr_b16 v[52:53], v9 offset:23040
    ds_read_b64_tr_b16 v[54:55], v9 offset:23616
    ds_read_b64_tr_b16 v[56:57], v9 offset:27648
    ds_read_b64_tr_b16 v[58:59], v9 offset:28224
    ds_read_b64_tr_b16 v[60:61], v9 offset:32256
    ds_read_b64_tr_b16 v[62:63], v9 offset:32832
    s_waitcnt lgkmcnt(0)
    ds_read_b64_tr_b16 v[96:97], v9 offset:36864
    ds_read_b64_tr_b16 v[98:99], v9 offset:37440
    ds_read_b64_tr_b16 v[100:101], v9 offset:41472
    ds_read_b64_tr_b16 v[102:103], v9 offset:42048
    ds_read_b64_tr_b16 v[104:105], v16 offset:0
    ds_read_b64_tr_b16 v[106:107], v16 offset:576
    ds_read_b64_tr_b16 v[108:109], v16 offset:4608
    ds_read_b64_tr_b16 v[110:111], v16 offset:5184
    s_waitcnt lgkmcnt(0)
    ds_read_b64_tr_b16 v[112:113], v16 offset:9216
    ds_read_b64_tr_b16 v[114:115], v16 offset:9792
    ds_read_b64_tr_b16 v[116:117], v16 offset:13824
    ds_read_b64_tr_b16 v[118:119], v16 offset:14400
    ds_read_b64_tr_b16 v[120:121], v16 offset:18432
    ds_read_b64_tr_b16 v[122:123], v16 offset:19008
    ds_read_b64_tr_b16 v[124:125], v16 offset:23040
    ds_read_b64_tr_b16 v[126:127], v16 offset:23616
    s_waitcnt lgkmcnt(0)
    ds_read_b64_tr_b16 v[128:129], v16 offset:27648
    ds_read_b64_tr_b16 v[130:131], v16 offset:28224
    ds_read_b64_tr_b16 v[132:133], v16 offset:32256
    ds_read_b64_tr_b16 v[134:135], v16 offset:32832
    ds_read_b64_tr_b16 v[136:137], v16 offset:36864
    ds_read_b64_tr_b16 v[138:139], v16 offset:37440
    ds_read_b64_tr_b16 v[140:141], v16 offset:41472
    ds_read_b64_tr_b16 v[142:143], v16 offset:42048
    s_waitcnt lgkmcnt(0)
    s_barrier
    v_mov_b32 v144, 0x3f803f80
    v_mov_b32 v145, 0x3f803f80
    v_mov_b32 v146, 0x3f803f80
    v_mov_b32 v147, 0x3f803f80
    s_nop 1
    v_mfma_f32_16x16x32_bf16 v[64:67], v[144:147], v[32:35], 0
    v_mfma_f32_16x16x32_bf16 v[64:67], v[144:147], v[36:39], v[64:67]
    v_mfma_f32_16x16x32_bf16 v[64:67], v[144:147], v[40:43], v[64:67]
    v_mfma_f32_16x16x32_bf16 v[64:67], v[144:147], v[44:47], v[64:67]
    v_mfma_f32_16x16x32_bf16 v[64:67], v[144:147], v[48:51], v[64:67]
    v_mfma_f32_16x16x32_bf16 v[64:67], v[144:147], v[52:55], v[64:67]
    v_mfma_f32_16x16x32_bf16 v[64:67], v[144:147], v[56:59], v[64:67]
    v_mfma_f32_16x16x32_bf16 v[64:67], v[144:147], v[60:63], v[64:67]
    v_mfma_f32_16x16x32_bf16 v[64:67], v[144:147], v[96:99], v[64:67]
    v_mfma_f32_16x16x32_bf16 v[64:67], v[144:147], v[100:103], v[64:67]
    v_mfma_f32_16x16x32_bf16 v[64:67], v[144:147], v[104:107], v[64:67]
    v_mfma_f32_16x16x32_bf16 v[64:67], v[144:147], v[108:111], v[64:67]
    v_mfma_f32_16x16x32_bf16 v[64:67], v[144:147], v[112:115], v[64:67]
    v_mfma_f32_16x16x32_bf16 v[64:67], v[144:147], v[116:119], v[64:67]
    v_mfma_f32_16x16x32_bf16 v[64:67], v[144:147], v[120:123], v[64:67]
    v_mfma_f32_16x16x32_bf16 v[64:67], v[144:147], v[124:127], v[64:67]
    v_mfma_f32_16x16x32_bf16 v[64:67], v[144:147], v[128:131], v[64:67]
    v_mfma_f32_16x16x32_bf16 v[64:67], v[144:147], v[132:135], v[64:67]
    v_mfma_f32_16x16x32_bf16 v[64:67], v[144:147], v[136:139], v[64:67]
    v_mfma_f32_16x16x32_bf16 v[64:67], v[144:147], v[140:143], v[64:67]
    s_nop 7
    v_mov_b32 v28, v64
    s_branch L_fp1a
L_ft2:
    global_load_dwordx4 v[96:99], v28, s[18:19] offset:0 nt
    global_load_dwordx4 v[100:103], v28, s[18:19] offset:128 nt
    global_load_dwordx4 v[104:107], v28, s[18:19] offset:256 nt
    global_load_dwordx4 v[108:111], v28, s[18:19] offset:384 nt
    global_load_dwordx4 v[112:115], v28, s[18:19] offset:512 nt
    global_load_dwordx4 v[116:119], v28, s[18:19] offset:640 nt
    global_load_dwordx4 v[120:123], v28, s[18:19] offset:768 nt
    global_load_dwordx4 v[124:127], v28, s[18:19] offset:896 nt
    global_load_dwordx4 v[128:131], v28, s[18:19] offset:1024 nt
    global_load_dwordx4 v[132:135], v28, s[18:19] offset:1152 nt
    s_barrier
    s_waitcnt vmcnt(9)
    ds_write_b128 v29, v[96:99] offset:0
    s_waitcnt vmcnt(8)
    ds_write_b128 v29, v[100:103] offset:128
    s_waitcnt vmcnt(7)
    ds_write_b128 v29, v[104:107] offset:256
    s_waitcnt vmcnt(6)
    ds_write_b128 v29, v[108:111] offset:384
    s_waitcnt vmcnt(5)
    ds_write_b128 v29, v[112:115] offset:512
    s_waitcnt vmcnt(4)
    ds_write_b128 v29, v[116:119] offset:640
    s_waitcnt vmcnt(3)
    ds_write_b128 v29, v[120:123] offset:768
    s_waitcnt vmcnt(2)
    ds_write_b128 v29, v[124:127] offset:896
    s_waitcnt vmcnt(1)
    ds_write_b128 v29, v[128:131] offset:1024
    s_waitcnt vmcnt(0)
    ds_write_b128 v29, v[132:135] offset:1152
    s_waitcnt lgkmcnt(0)
    s_cmp_lg_u32 s3, 10
    s_cbranch_scc1 L_fp1a
    s_call_b64 s[50:51], L_fxchk
L_fp1a:
    s_barrier
    s_cmp_ge_u32 s3, 10
    s_cbranch_scc1 L_fin
    s_cmp_lt_u32 s3, 4
    s_cbranch_scc1 L_fp1b
    s_cmp_ge_u32 s3, 8
    s_cbranch_scc1 L_fp1b
    s_mul_i32 s28, s45, 320
    v_mul_u32_u24 v9, 1296, v22
    v_add3_u32 v9, v9, v23, s28
    ds_read_b64_tr_b16 v[32:33], v9 offset:0
    ds_read_b64_tr_b16 v[34:35], v9 offset:5184
    ds_read_b64_tr_b16 v[36:37], v9 offset:41472
    ds_read_b64_tr_b16 v[38:39], v9 offset:46656
    ds_read_b64_tr_b16 v[40:41], v9 offset:32
    ds_read_b64_tr_b16 v[42:43], v9 offset:5216
    ds_read_b64_tr_b16 v[44:45], v9 offset:41504
    ds_read_b64_tr_b16 v[46:47], v9 offset:46688
    s_waitcnt lgkmcnt(0)
    ds_read_b64_tr_b16 v[48:49], v9 offset:64
    ds_read_b64_tr_b16 v[50:51], v9 offset:5248
    ds_read_b64_tr_b16 v[52:53], v9 offset:41536
    ds_read_b64_tr_b16 v[54:55], v9 offset:46720
    ds_read_b64_tr_b16 v[56:57], v9 offset:96
    ds_read_b64_tr_b16 v[58:59], v9 offset:5280
    ds_read_b64_tr_b16 v[60:61], v9 offset:41568
    ds_read_b64_tr_b16 v[62:63], v9 offset:46752
    s_waitcnt lgkmcnt(0)
    ds_read_b64_tr_b16 v[96:97], v9 offset:128
    ds_read_b64_tr_b16 v[98:99], v9 offset:5312
    ds_read_b64_tr_b16 v[100:101], v9 offset:41600
    ds_read_b64_tr_b16 v[102:103], v9 offset:46784
    ds_read_b64_tr_b16 v[104:105], v9 offset:160
    ds_read_b64_tr_b16 v[106:107], v9 offset:5344
    ds_read_b64_tr_b16 v[108:109], v9 offset:41632
    ds_read_b64_tr_b16 v[110:111], v9 offset:46816
    s_waitcnt lgkmcnt(0)
    ds_read_b64_tr_b16 v[112:113], v9 offset:192
    ds_read_b64_tr_b16 v[114:115], v9 offset:5376
    ds_read_b64_tr_b16 v[116:117], v9 offset:41664
    ds_read_b64_tr_b16 v[118:119], v9 offset:46848
    ds_read_b64_tr_b16 v[120:121], v9 offset:224
    ds_read_b64_tr_b16 v[122:123], v9 offset:5408
    ds_read_b64_tr_b16 v[124:125], v9 offset:41696
    ds_read_b64_tr_b16 v[126:127], v9 offset:46880
    s_waitcnt lgkmcnt(0)
    ds_read_b64_tr_b16 v[128:129], v9 offset:256
    ds_read_b64_tr_b16 v[130:131], v9 offset:5440
    ds_read_b64_tr_b16 v[132:133], v9 offset:41728
    ds_read_b64_tr_b16 v[134:135], v9 offset:46912
    ds_read_b64_tr_b16 v[136:137], v9 offset:288
    ds_read_b64_tr_b16 v[138:139], v9 offset:5472
    ds_read_b64_tr_b16 v[140:141], v9 offset:41760
    ds_read_b64_tr_b16 v[142:143], v9 offset:46944
    s_waitcnt lgkmcnt(0)
L_fp1b:
    v_lshlrev_b32 v11, 4, v1
    v_add_u32 v11, 92160, v11
    v_lshlrev_b32 v12, 2, v1
    v_add_u32 v12, 93184, v12
    s_lshl_b32 s28, s45, 5
    v_lshlrev_b32 v26, 1, v10
    v_add_u32 v26, s28, v26
    v_add_u32 v26, 93440, v26
    s_mov_b32 s44, 0x3f803f80
    v_mov_b32 v9, 93696
    ds_read_b64 v[16:17], v9
    s_setprio 0
    s_waitcnt lgkmcnt(0)
    v_readfirstlane_b32 s47, v16
    v_add_u32 v13, v13, v17
    v_add_u32 v14, v14, v17
    v_add_u32 v15, v15, v17
    v_add_u32 v25, v25, v17
    s_mov_b64 s[52:53], exec
    s_mov_b64 s[54:55], exec
    s_mov_b64 s[56:57], exec
    s_mov_b64 s[58:59], exec
    s_mov_b64 s[62:63], exec
L_hpoll:
    s_mov_b64 exec, s[52:53]
    global_load_dwordx4 v[64:67], v13, s[24:25] sc1
    s_mov_b64 exec, s[54:55]
    global_load_dwordx4 v[68:71], v14, s[24:25] sc1
    s_mov_b64 exec, s[56:57]
    global_load_dwordx4 v[72:75], v15, s[24:25] sc1
    s_mov_b64 exec, s[58:59]
    global_load_dwordx4 v[76:79], v25, s[24:25] sc1
    s_mov_b32 s60, 0
    s_waitcnt vmcnt(0)
    s_mov_b64 exec, s[52:53]
    s_cbranch_execz L_sk_42
    v_xor_b32 v64, s34, v64
    v_xor_b32 v65, s34, v65
    v_xor_b32 v66, s34, v66
    v_xor_b32 v67, s34, v67
    v_or3_b32 v16, v64, v65, v66
    v_or_b32 v16, v16, v67
    v_and_b32 v16, s35, v16
    v_cmpx_ne_u32 vcc, 0, v16
    s_mov_b64 s[52:53], exec
    s_cbranch_execz L_sk_42
    s_bitset1_b32 s60, 0
L_sk_42:
    s_mov_b64 exec, s[54:55]
    s_cbranch_execz L_sk_43
    v_xor_b32 v68, s34, v68
    v_xor_b32 v69, s34, v69
    v_xor_b32 v70, s34, v70
    v_xor_b32 v71, s34, v71
    v_or3_b32 v16, v68, v69, v70
    v_or_b32 v16, v16, v71
    v_and_b32 v16, s35, v16
    v_cmpx_ne_u32 vcc, 0, v16
    s_mov_b64 s[54:55], exec
    s_cbranch_execz L_sk_43
    s_bitset1_b32 s60, 1
L_sk_43:
    s_mov_b64 exec, s[56:57]
    s_cbranch_execz L_sk_44
    v_xor_b32 v72, s34, v72
    v_xor_b32 v73, s34, v73
    v_xor_b32 v74, s34, v74
    v_xor_b32 v75, s34, v75
    v_or3_b32 v16, v72, v73, v74
    v_or_b32 v16, v16, v75
    v_and_b32 v16, s35, v16
    v_cmpx_ne_u32 vcc, 0, v16
    s_mov_b64 s[56:57], exec
    s_cbranch_execz L_sk_44
    s_bitset1_b32 s60, 2
L_sk_44:
    s_mov_b64 exec, s[58:59]
    s_cbranch_execz L_sk_45
    v_xor_b32 v76, s34, v76
    v_xor_b32 v77, s34, v77
    v_xor_b32 v78, s34, v78
    v_xor_b32 v79, s34, v79
    v_or3_b32 v16, v76, v77, v78
    v_or_b32 v16, v16, v79
    v_and_b32 v16, s35, v16
    v_cmpx_ne_u32 vcc, 0, v16
    s_mov_b64 s[58:59], exec
    s_cbranch_execz L_sk_45
    s_bitset1_b32 s60, 3
L_sk_45:
    s_cmp_lg_u32 s60, 0
    s_cbranch_scc1 L_hpoll_more
L_hpoll_ok:
    s_mov_b64 exec, s[62:63]
    s_setprio 3
    v_pk_add_f32 v[64:65], v[64:65], v[68:69]
    v_pk_add_f32 v[66:67], v[66:67], v[70:71]
    v_pk_add_f32 v[72:73], v[72:73], v[76:77]
    v_pk_add_f32 v[74:75], v[74:75], v[78:79]
    v_pk_add_f32 v[64:65], v[64:65], v[72:73]
    v_pk_add_f32 v[66:67], v[66:67], v[74:75]
    s_nop 1
    v_permlane32_swap_b32 v64, v66
    v_permlane32_swap_b32 v65, v67
    v_pk_add_f32 v[64:65], v[64:65], v[66:67]
    s_nop 1
    v_permlane16_swap_b32 v64, v65
    v_add_f32 v64, v64, v65
    v_cvt_pk_bf16_f32 v16, v64, v64
    v_and_b32 v16, 0xffff0000, v16
    v_add_f32 v16, v16, v24
    v_cvt_pk_bf16_f32 v16, v16, v16
    ds_write_b16 v27, v16
    s_cmp_ge_u32 s3, 4
    s_waitcnt lgkmcnt(0)
    s_barrier
    s_cbranch_scc1 L_f2
    ds_read_b128 v[68:71], v11
    ds_read_b32 v72, v12
    ds_read_b128 v[144:147], v31 offset:0
    ds_read_b128 v[148:151], v31 offset:64
    ds_read_b128 v[152:155], v31 offset:128
    ds_read_b128 v[156:159], v31 offset:192
    ds_read_b128 v[160:163], v31 offset:256
    ds_read_b128 v[80:83], v31 offset:320
    ds_read_b128 v[84:87], v31 offset:384
    ds_read_b128 v[88:91], v31 offset:448
    ds_read_b128 v[92:95], v31 offset:512
    ds_read_b128 v[76:79], v31 offset:576
    s_waitcnt lgkmcnt(7)
    v_mfma_f32_16x16x32_bf16 v[64:67], v[144:147], v[32:35], 0
    ds_read_b128 v[144:147], v31 offset:640
    v_dot2_f32_bf16 v16, v68, s44, 0
    v_dot2_f32_bf16 v18, v68, v68, 0
    v_mfma_f32_16x16x32_bf16 v[64:67], v[148:151], v[36:39], v[64:67]
    ds_read_b128 v[148:151], v31 offset:704
    v_dot2_f32_bf16 v16, v69, s44, v16
    v_dot2_f32_bf16 v18, v69, v69, v18
    v_mfma_f32_16x16x32_bf16 v[64:67], v[152:155], v[40:43], v[64:67]
    ds_read_b128 v[152:155], v31 offset:768
    v_dot2_f32_bf16 v16, v70, s44, v16
    v_dot2_f32_bf16 v18, v70, v70, v18
    s_waitcnt lgkmcnt(7)
    v_mfma_f32_16x16x32_bf16 v[64:67], v[156:159], v[44:47], v[64:67]
    ds_read_b128 v[156:159], v31 offset:832
    v_dot2_f32_bf16 v16, v71, s44, v16
    v_dot2_f32_bf16 v18, v71, v71, v18
    v_mfma_f32_16x16x32_bf16 v[64:67], v[160:163], v[48:51], v[64:67]
    ds_read_b128 v[160:163], v31 offset:896
    v_dot2_f32_bf16 v16, v72, s44, v16
    v_dot2_f32_bf16 v18, v72, v72, v18
    v_mfma_f32_16x16x32_bf16 v[64:67], v[80:83], v[52:55], v[64:67]
    ds_read_b128 v[80:83], v31 offset:960
    v_add_f32_dpp v16, v16, v16 quad_perm:[1,0,3,2] row_mask:0xf bank_mask:0xf
    v_add_f32_dpp v18, v18, v18 quad_perm:[1,0,3,2] row_mask:0xf bank_mask:0xf
    s_waitcnt lgkmcnt(6)
    v_mfma_f32_16x16x32_bf16 v[64:67], v[84:87], v[56:59], v[64:67]
    ds_read_b128 v[84:87], v31 offset:1024
    v_add_f32_dpp v16, v16, v16 quad_perm:[2,3,0,1] row_mask:0xf bank_mask:0xf
    v_add_f32_dpp v18, v18, v18 quad_perm:[2,3,0,1] row_mask:0xf bank_mask:0xf
    v_mfma_f32_16x16x32_bf16 v[64:67], v[88:91], v[60:63], v[64:67]
    ds_read_b128 v[88:91], v31 offset:1088
    v_add_f32_dpp v16, v16, v16 row_half_mirror row_mask:0xf bank_mask:0xf
    v_add_f32_dpp v18, v18, v18 row_half_mirror row_mask:0xf bank_mask:0xf
    v_mfma_f32_16x16x32_bf16 v[64:67], v[92:95], v[96:99], v[64:67]
    ds_read_b128 v[92:95], v31 offset:1152
    v_add_f32_dpp v16, v16, v16 row_ror:8 row_mask:0xf bank_mask:0xf
    v_add_f32_dpp v18, v18, v18 row_ror:8 row_mask:0xf bank_mask:0xf
    v_mfma_f32_16x16x32_bf16 v[64:67], v[76:79], v[100:103], v[64:67]
    ds_read_b128 v[76:79], v31 offset:1216
    v_mov_b32 v17, v16
    v_mov_b32 v19, v18
    s_waitcnt lgkmcnt(7)
    v_mfma_f32_16x16x32_bf16 v[64:67], v[144:147], v[104:107], v[64:67]
    v_permlane16_swap_b32 v16, v17
    v_permlane16_swap_b32 v18, v19
    v_mfma_f32_16x16x32_bf16 v[64:67], v[148:151], v[108:111], v[64:67]
    v_add_f32 v16, v16, v17
    v_add_f32 v18, v18, v19
    v_mfma_f32_16x16x32_bf16 v[64:67], v[152:155], v[112:115], v[64:67]
    v_mov_b32 v17, v16
    v_mov_b32 v19, v18
    s_waitcnt lgkmcnt(4)
    v_mfma_f32_16x16x32_bf16 v[64:67], v[156:159], v[116:119], v[64:67]
    v_permlane32_swap_b32 v16, v17
    v_permlane32_swap_b32 v18, v19
    v_mfma_f32_16x16x32_bf16 v[64:67], v[160:163], v[120:123], v[64:67]
    v_add_f32 v16, v16, v17
    v_add_f32 v18, v18, v19
    v_mfma_f32_16x16x32_bf16 v[64:67], v[80:83], v[124:127], v[64:67]
    v_mul_f32 v16, 0x3acccccd, v16
    v_mul_f32 v18, 0x3acccccd, v18
    s_waitcnt lgkmcnt(0)
    v_mfma_f32_16x16x32_bf16 v[64:67], v[84:87], v[128:131], v[64:67]
    v_fma_f32 v18, -v16, v16, v18
    v_max_f32 v18, 0, v18
    v_mfma_f32_16x16x32_bf16 v[64:67], v[88:91], v[132:135], v[64:67]
    v_add_f32 v18, 0x3727c5ac, v18
    v_rsq_f32 v18, v18
    v_mfma_f32_16x16x32_bf16 v[64:67], v[92:95], v[136:139], v[64:67]
    v_mul_f32 v16, v16, v28
    v_mfma_f32_16x16x32_bf16 v[64:67], v[76:79], v[140:143], v[64:67]
    s_nop 7
    v_sub_f32 v16, v64, v16
    v_mul_f32 v16, v16, v18
    v_mul_f32 v17, 0xbfb8aa3b, v16
    v_exp_f32 v17, v17
    s_nop 0
    v_add_f32 v17, 1.0, v17
    v_rcp_f32 v17, v17
    s_nop 0
    v_mul_f32 v16, v16, v17
    v_cvt_pk_bf16_f32 v16, v16, v16
    ds_write_b16 v26, v16
    s_waitcnt lgkmcnt(0)
    s_barrier
    s_branch L_fin
L_f2:
    s_cmp_ge_u32 s3, 8
    s_cbranch_scc1 L_fin
    s_barrier
    ds_read_b128 v[144:147], v4 offset:0
    ds_read_b128 v[148:151], v4 offset:64
    ds_read_b128 v[152:155], v5 offset:0
    ds_read_b128 v[156:159], v5 offset:64
    ds_read_b128 v[160:163], v6 offset:0
    ds_read_b128 v[80:83], v6 offset:64
    ds_read_b128 v[84:87], v7 offset:0
    ds_read_b128 v[88:91], v7 offset:64
    s_waitcnt lgkmcnt(7)
    v_mfma_f32_16x16x32_bf16 v[64:67], v[144:147], v[32:35], 0
    s_waitcnt lgkmcnt(6)
    v_mfma_f32_16x16x32_bf16 v[64:67], v[148:151], v[36:39], v[64:67]
    s_waitcnt lgkmcnt(5)
    v_mfma_f32_16x16x32_bf16 v[64:67], v[152:155], v[40:43], v[64:67]
    s_waitcnt lgkmcnt(4)
    v_mfma_f32_16x16x32_bf16 v[64:67], v[156:159], v[44:47], v[64:67]
    s_waitcnt lgkmcnt(3)
    v_mfma_f32_16x16x32_bf16 v[64:67], v[160:163], v[48:51], v[64:67]
    s_waitcnt lgkmcnt(2)
    v_mfma_f32_16x16x32_bf16 v[64:67], v[80:83], v[52:55], v[64:67]
    s_waitcnt lgkmcnt(1)
    v_mfma_f32_16x16x32_bf16 v[64:67], v[84:87], v[56:59], v[64:67]
    s_waitcnt lgkmcnt(0)
    v_mfma_f32_16x16x32_bf16 v[64:67], v[88:91], v[60:63], v[64:67]
    v_mfma_f32_16x16x32_bf16 v[68:71], v[144:147], v[96:99], 0
    v_mfma_f32_16x16x32_bf16 v[68:71], v[148:151], v[100:103], v[68:71]
    v_mfma_f32_16x16x32_bf16 v[68:71], v[152:155], v[104:107], v[68:71]
    v_mfma_f32_16x16x32_bf16 v[68:71], v[156:159], v[108:111], v[68:71]
    v_mfma_f32_16x16x32_bf16 v[68:71], v[160:163], v[112:115], v[68:71]
    v_mfma_f32_16x16x32_bf16 v[68:71], v[80:83], v[116:119], v[68:71]
    s_nop 1
    v_bfi_b32 v64, s35, v8, v64
    v_mfma_f32_16x16x32_bf16 v[68:71], v[84:87], v[120:123], v[68:71]
    v_mfma_f32_16x16x32_bf16 v[68:71], v[88:91], v[124:127], v[68:71]
    v_mfma_f32_16x16x32_bf16 v[72:75], v[144:147], v[128:131], 0
    v_mfma_f32_16x16x32_bf16 v[72:75], v[148:151], v[132:135], v[72:75]
    v_mfma_f32_16x16x32_bf16 v[72:75], v[152:155], v[136:139], v[72:75]
    v_mfma_f32_16x16x32_bf16 v[72:75], v[156:159], v[140:143], v[72:75]
    s_cmp_lg_u32 s47, 0
    s_cbranch_scc0 L_ds_46
    global_store_dword v30, v64, s[24:25]
    s_nop 0
    v_bfi_b32 v68, s35, v8, v68
    global_store_dword v30, v68, s[24:25] offset:256
    s_nop 1
    v_bfi_b32 v72, s35, v8, v72
    s_mov_b64 exec, 0xffffffff
    global_store_dword v30, v72, s[24:25] offset:512
L_ds_47:
    s_branch L_fin
L_redu:
    s_cmp_lg_u32 s3, 10
    s_cbranch_scc1 L_redu2
    s_setprio 3
    s_mov_b32 s29, 0
    s_call_b64 s[50:51], L_fxcc
    s_setprio 0
L_redu2:
    s_sub_u32 s44, s101, 24
    s_and_b32 s28, s44, 1
    s_add_u32 s14, s28, 14
    s_lshr_b32 s29, s44, 1
    s_mul_i32 s48, s29, 3
    s_lshl1_add_u32 s30, s29, 2
    s_cmp_lt_u32 s29, 2
    s_cselect_b32 s48, s48, s30
    s_cselect_b32 s45, 3, 2
    s_cmp_ge_u32 s3, 6
    s_cselect_b32 s28, 1, 0
    s_cselect_b32 s29, 6, 0
    s_lshl1_add_u32 s46, s14, s28
    s_sub_u32 s43, s3, s29
    s_mul_i32 s28, s46, 6
    s_add_u32 s28, s28, s43
    s_mul_i32 s28, s28, 40960
    s_lshl_b32 s29, s48, 7
    s_add_u32 s28, s28, s29
    v_and_b32 v28, 1, v2
    v_lshlrev_b32 v28, 4, v28
    v_lshrrev_b32 v29, 1, v2
    v_add_u32 v28, v28, v29
    v_mul_u32_u24 v28, 1280, v28
    v_add3_u32 v28, v28, v3, s28
    s_cmp_eq_u32 s45, 2
    s_cbranch_scc1 L_xo2
    global_load_dwordx4 v[100:103], v28, s[12:13] offset:0 nt
    global_load_dwordx4 v[116:119], v28, s[12:13] offset:128 nt
    global_load_dwordx4 v[132:135], v28, s[12:13] offset:256 nt
    v_add_u32 v28, 5120, v28
    global_load_dwordx4 v[104:107], v28, s[12:13] offset:0 nt
    s_waitcnt vmcnt(3)
    global_load_dwordx4 v[120:123], v28, s[12:13] offset:128 nt
    s_waitcnt vmcnt(3)
    global_load_dwordx4 v[136:139], v28, s[12:13] offset:256 nt
    v_add_u32 v28, 5120, v28
    s_waitcnt vmcnt(3)
    global_load_dwordx4 v[108:111], v28, s[12:13] offset:0 nt
    s_waitcnt vmcnt(3)
    global_load_dwordx4 v[124:127], v28, s[12:13] offset:128 nt
    s_waitcnt vmcnt(3)
    global_load_dwordx4 v[140:143], v28, s[12:13] offset:256 nt
    v_add_u32 v28, 5120, v28
    s_waitcnt vmcnt(3)
    global_load_dwordx4 v[112:115], v28, s[12:13] offset:0 nt
    s_waitcnt vmcnt(3)
    global_load_dwordx4 v[128:131], v28, s[12:13] offset:128 nt
    s_waitcnt vmcnt(3)
    global_load_dwordx4 v[144:147], v28, s[12:13] offset:256 nt
    s_branch L_xo3
L_xo2:
    global_load_dwordx4 v[100:103], v28, s[12:13] offset:0 nt
    global_load_dwordx4 v[116:119], v28, s[12:13] offset:128 nt
    v_add_u32 v28, 5120, v28
    global_load_dwordx4 v[104:107], v28, s[12:13] offset:0 nt
    global_load_dwordx4 v[120:123], v28, s[12:13] offset:128 nt
    v_add_u32 v28, 5120, v28
    s_waitcnt vmcnt(3)
    global_load_dwordx4 v[108:111], v28, s[12:13] offset:0 nt
    s_waitcnt vmcnt(3)
    global_load_dwordx4 v[124:127], v28, s[12:13] offset:128 nt
    v_add_u32 v28, 5120, v28
    s_waitcnt vmcnt(3)
    global_load_dwordx4 v[112:115], v28, s[12:13] offset:0 nt
    s_waitcnt vmcnt(3)
    global_load_dwordx4 v[128:131], v28, s[12:13] offset:128 nt
L_xo3:
    v_and_b32 v10, 7, v1
    v_lshrrev_b32 v9, 1, v10
    v_and_b32 v22, 1, v10
    v_mov_b32 v23, 0xffff
    v_lshlrev_b32 v22, 4, v22
    v_lshlrev_b32 v23, v22, v23
    v_cmp_eq_u32 vcc, 0, v9
    s_nop 1
    v_cndmask_b32 v4, 0, v23, vcc
    v_cmp_eq_u32 vcc, 1, v9
    s_nop 1
    v_cndmask_b32 v5, 0, v23, vcc
    v_cmp_eq_u32 vcc, 2, v9
    s_nop 1
    v_cndmask_b32 v6, 0, v23, vcc
    v_cmp_eq_u32 vcc, 3, v9
    s_nop 1
    v_cndmask_b32 v7, 0, v23, vcc
    s_mov_b32 s100, 4194304
    s_mov_b32 s36, 0x00ff00ff
    s_mov_b32 s37, 0xff00ff00
    s_mov_b32 s38, 0x00ff00ff
    s_mov_b32 s39, 0x00ff00ff
    s_mov_b32 s35, 1023
    v_lshrrev_b32 v9, 5, v1
    v_bfe_u32 v22, v1, 4, 1
    v_lshlrev_b32 v22, 4, v22
    v_lshl_add_u32 v22, v3, 1, v22
    s_mul_i32 s28, s3, 768
    v_mul_u32_u24 v27, 384, v9
    v_add3_u32 v27, v27, v22, s28
    s_mov_b32 s40, 0
    s_mov_b32 s41, 0xff000000
    s_mov_b32 s30, 524288
    s_lshl_b32 s28, s46, 14
    s_add_u32 s28, s28, s30
    v_min_u32 v12, 6, v2
    v_lshl_add_u32 v12, v12, 10, s28
    s_lshl_b32 s29, s43, 7
    v_add3_u32 v30, v12, v3, s29
    v_add_u32 v12, 768, v12
    s_lshr_b32 s28, s3, 1
    s_and_b32 s29, s3, 1
    s_lshl_b32 s29, s29, 7
    s_mul_i32 s30, s28, 9216
    s_add_u32 s30, s30, s29
    v_mul_u32_u24 v26, 1152, v2
    v_add3_u32 v26, v26, v3, s30
    s_add_u32 s28, s28, s48
    s_lshl_b32 s28, s28, 8
    s_add_u32 s28, s28, s29
    s_and_b32 s29, s14, 1
    s_lshl_b32 s29, s29, 12
    s_add_u32 s28, s28, s29
    s_mov_b32 s30, 770048
    s_add_u32 s28, s28, s30
    v_lshrrev_b32 v31, 4, v1
    v_lshlrev_b32 v31, 2, v31
    v_add3_u32 v31, v31, v3, s28
    s_mul_i32 s28, s44, 3
    s_add_u32 s47, s28, s3
    s_min_u32 s42, s47, 19
    v_mul_u32_u24 v9, 2560, v2
    s_lshl_b32 s31, s42, 7
    s_add_u32 s32, s31, 786432
    v_add3_u32 v11, v9, v3, s32
    s_mov_b32 s32, 655360
    s_add_u32 s32, s32, s31
    v_lshrrev_b32 v14, 1, v2
    v_lshlrev_b32 v14, 14, v14
    v_and_b32 v16, 1, v2
    v_lshl_add_u32 v14, v16, 12, v14
    v_add3_u32 v14, v14, v3, s32
    v_add_u32 v25, 65536, v14
    s_lshl_b32 s29, s42, 6
    v_lshrrev_b32 v15, 4, v1
    v_lshlrev_b32 v15, 1, v15
    v_lshrrev_b32 v16, 1, v3
    v_add3_u32 v15, v15, v16, s29
    v_mov_b32 v24, 0
    global_load_short_d16_hi v24, v15, s[4:5]
    s_waitcnt lgkmcnt(0)
    s_cmp_eq_u32 s3, 10
    s_cbranch_scc0 L_xo4
    v_mov_b32 v13, v12
    s_call_b64 s[50:51], L_fxchk
    v_mov_b32 v12, v13
    s_branch L_xo5
L_xo4:
    s_add_u32 s33, s34, 1
    s_and_b32 s34, s33, s35
    v_mov_b32 v8, s34
L_xo5:
    s_barrier
    v_mov_b32 v9, 93696
    ds_read_b64 v[16:17], v9
    s_waitcnt lgkmcnt(0)
    v_readfirstlane_b32 s49, v16
    v_add_u32 v12, v12, v17
    v_add_u32 v30, v30, v17
    v_add_u32 v14, v14, v17
    v_add_u32 v25, v25, v17
L_xop_g:
    s_mov_b64 s[52:53], -1
    s_mov_b64 s[54:55], -1
    global_load_dwordx4 v[48:51], v12, s[24:25] sc1
    global_load_dwordx4 v[44:47], v30, s[24:25] sc1
L_xop_a:
    s_waitcnt vmcnt(0)
    s_mov_b64 exec, s[52:53]
    v_xor_b32 v44, s34, v44
    v_xor_b32 v45, s34, v45
    v_xor_b32 v46, s34, v46
    v_xor_b32 v47, s34, v47
    v_or3_b32 v16, v44, v45, v46
    v_or_b32 v16, v16, v47
    v_and_b32 v16, s35, v16
    v_cmpx_ne_u32 vcc, 0, v16
    s_mov_b64 s[52:53], exec
    global_load_dwordx4 v[44:47], v30, s[24:25] sc1
    s_mov_b64 exec, s[54:55]
    v_xor_b32 v48, s34, v48
    v_xor_b32 v49, s34, v49
    v_xor_b32 v50, s34, v50
    v_xor_b32 v51, s34, v51
    v_or3_b32 v16, v48, v49, v50
    v_or_b32 v16, v16, v51
    v_and_b32 v16, s35, v16
    v_cmpx_ne_u32 vcc, 0, v16
    s_cbranch_execnz L_xop_s
L_xop_w:
    s_mov_b64 exec, -1
    v_mov_b32 v16, v48
    s_nop 1
    v_max_f32_dpp v16, v16, v16 row_ror:8 row_mask:0xf bank_mask:0xf
    v_mov_b32 v17, v16
    s_nop 1
    v_permlane16_swap_b32 v16, v17
    v_max_f32 v16, v16, v17
    v_mov_b32 v17, v16
    s_nop 1
    v_permlane32_swap_b32 v16, v17
    v_max_f32 v16, v16, v17
    v_sub_f32 v16, v48, v16
    v_mul_f32 v16, 0x3fb8aa3b, v16
    v_exp_f32 v18, v16
    s_nop 0
    v_cndmask_b32 v18, v18, 0, s[40:41]
    v_mul_f32 v19, v18, v49
    s_nop 1
    v_add_f32_dpp v19, v19, v19 row_ror:8 row_mask:0xf bank_mask:0xf
    v_mov_b32 v17, v19
    s_nop 1
    v_permlane16_swap_b32 v19, v17
    v_add_f32 v19, v19, v17
    v_mov_b32 v17, v19
    s_nop 1
    v_permlane32_swap_b32 v19, v17
    v_add_f32 v19, v19, v17
    v_rcp_f32 v19, v19
    s_nop 0
    v_mul_f32 v18, v18, v19
    s_mov_b64 exec, s[52:53]
    s_cbranch_execnz L_xop_in
    s_branch L_xop_out
L_xop:
    global_load_dwordx4 v[44:47], v30, s[24:25] sc1
    s_sub_u32 s100, s100, 1
    s_cbranch_scc1 L_xop_out
L_xop_in:
    s_waitcnt vmcnt(0)
    v_xor_b32 v44, s34, v44
    v_xor_b32 v45, s34, v45
    v_xor_b32 v46, s34, v46
    v_xor_b32 v47, s34, v47
    v_or3_b32 v16, v44, v45, v46
    v_or_b32 v16, v16, v47
    v_and_b32 v16, s35, v16
    v_cmpx_ne_u32 vcc, 0, v16
    s_cbranch_execnz L_xop
L_xop_out:
    s_mov_b64 exec, -1
    s_setprio 3
    v_pk_mul_f32 v[44:45], v[44:45], v[18:19] op_sel_hi:[1,0]
    v_pk_mul_f32 v[46:47], v[46:47], v[18:19] op_sel_hi:[1,0]
    s_nop 1
    v_permlane32_swap_b32 v44, v46
    v_permlane32_swap_b32 v45, v47
    v_pk_add_f32 v[44:45], v[44:45], v[46:47]
    s_nop 1
    v_permlane16_swap_b32 v44, v45
    v_add_f32 v44, v44, v45
    s_nop 1
    v_add_f32_dpp v44, v44, v44 row_ror:8 row_mask:0xf bank_mask:0xf
    v_cvt_pk_bf16_f32 v16, v44, v44
    s_nop 1
    v_mov_b32_dpp v16, v16 row_shr:4 row_mask:0xf bank_mask:0x2
    s_nop 1
    v_mov_b32_dpp v16, v16 row_shl:4 row_mask:0xf bank_mask:0x4
    s_cmp_eq_u32 s45, 2
    s_cbranch_scc1 L_xm2
    v_mov_b32_dpp v20, v16 quad_perm:[0,0,0,0] row_mask:0xf bank_mask:0xf
    v_and_b32 v68, v20, v4
    v_and_b32 v69, v20, v5
    v_and_b32 v70, v20, v6
    v_and_b32 v71, v20, v7
    v_mov_b32_dpp v21, v16 quad_perm:[1,1,1,1] row_mask:0xf bank_mask:0xf
    v_and_b32 v72, v21, v4
    v_and_b32 v73, v21, v5
    v_and_b32 v74, v21, v6
    v_and_b32 v75, v21, v7
    v_mfma_f32_16x16x32_bf16 v[52:55], v[68:71], v[100:103], 0
    v_mfma_f32_16x16x32_bf16 v[56:59], v[68:71], v[116:119], 0
    v_mfma_f32_16x16x32_bf16 v[60:63], v[68:71], v[132:135], 0
    v_mov_b32_dpp v22, v16 quad_perm:[2,2,2,2] row_mask:0xf bank_mask:0xf
    v_and_b32 v76, v22, v4
    v_and_b32 v77, v22, v5
    v_and_b32 v78, v22, v6
    v_and_b32 v79, v22, v7
    v_mfma_f32_16x16x32_bf16 v[52:55], v[72:75], v[104:107], v[52:55]
    v_mfma_f32_16x16x32_bf16 v[56:59], v[72:75], v[120:123], v[56:59]
    v_mfma_f32_16x16x32_bf16 v[60:63], v[72:75], v[136:139], v[60:63]
    v_mov_b32_dpp v23, v16 quad_perm:[3,3,3,3] row_mask:0xf bank_mask:0xf
    v_and_b32 v80, v23, v4
    v_and_b32 v81, v23, v5
    v_and_b32 v82, v23, v6
    v_and_b32 v83, v23, v7
    v_mfma_f32_16x16x32_bf16 v[52:55], v[76:79], v[108:111], v[52:55]
    v_mfma_f32_16x16x32_bf16 v[56:59], v[76:79], v[124:127], v[56:59]
    v_mfma_f32_16x16x32_bf16 v[60:63], v[76:79], v[140:143], v[60:63]
    v_mfma_f32_16x16x32_bf16 v[52:55], v[80:83], v[112:115], v[52:55]
    v_mfma_f32_16x16x32_bf16 v[56:59], v[80:83], v[128:131], v[56:59]
    v_mfma_f32_16x16x32_bf16 v[60:63], v[80:83], v[144:147], v[60:63]
    s_mov_b64 exec, s[36:37]
    s_nop 4
    ds_write_b128 v27, v[52:55] offset:0
    ds_write_b128 v27, v[56:59] offset:9216
    ds_write_b128 v27, v[60:63] offset:18432
    s_branch L_xm3
L_xm2:
    v_mov_b32_dpp v20, v16 quad_perm:[0,0,0,0] row_mask:0xf bank_mask:0xf
    v_and_b32 v68, v20, v4
    v_and_b32 v69, v20, v5
    v_and_b32 v70, v20, v6
    v_and_b32 v71, v20, v7
    v_mov_b32_dpp v21, v16 quad_perm:[1,1,1,1] row_mask:0xf bank_mask:0xf
    v_and_b32 v72, v21, v4
    v_and_b32 v73, v21, v5
    v_and_b32 v74, v21, v6
    v_and_b32 v75, v21, v7
    v_mfma_f32_16x16x32_bf16 v[52:55], v[68:71], v[100:103], 0
    v_mfma_f32_16x16x32_bf16 v[56:59], v[68:71], v[116:119], 0
    v_mov_b32_dpp v22, v16 quad_perm:[2,2,2,2] row_mask:0xf bank_mask:0xf
    v_and_b32 v76, v22, v4
    v_and_b32 v77, v22, v5
    v_and_b32 v78, v22, v6
    v_and_b32 v79, v22, v7
    v_mfma_f32_16x16x32_bf16 v[52:55], v[72:75], v[104:107], v[52:55]
    v_mfma_f32_16x16x32_bf16 v[56:59], v[72:75], v[120:123], v[56:59]
    v_mov_b32_dpp v23, v16 quad_perm:[3,3,3,3] row_mask:0xf bank_mask:0xf
    v_and_b32 v80, v23, v4
    v_and_b32 v81, v23, v5
    v_and_b32 v82, v23, v6
    v_and_b32 v83, v23, v7
    v_mfma_f32_16x16x32_bf16 v[52:55], v[76:79], v[108:111], v[52:55]
    v_mfma_f32_16x16x32_bf16 v[56:59], v[76:79], v[124:127], v[56:59]
    v_mfma_f32_16x16x32_bf16 v[52:55], v[80:83], v[112:115], v[52:55]
    v_mfma_f32_16x16x32_bf16 v[56:59], v[80:83], v[128:131], v[56:59]
    s_mov_b64 exec, s[36:37]
    s_nop 5
    ds_write_b128 v27, v[52:55] offset:0
    ds_write_b128 v27, v[56:59] offset:9216
L_xm3:
    s_mov_b64 exec, -1
    s_lshl_b32 s28, s45, 1
    s_waitcnt lgkmcnt(0)
    s_barrier
    s_cmp_ge_u32 s3, s28
    s_cbranch_scc1 L_fin
    ds_read_b128 v[52:55], v26 offset:0
    ds_read_b128 v[56:59], v26 offset:384
    ds_read_b128 v[60:63], v26 offset:768
    s_waitcnt lgkmcnt(0)
    v_pk_add_f32 v[52:53], v[52:53], v[56:57]
    v_pk_add_f32 v[54:55], v[54:55], v[58:59]
    v_pk_add_f32 v[52:53], v[52:53], v[60:61]
    v_pk_add_f32 v[54:55], v[54:55], v[62:63]
    s_nop 1
    v_permlane32_swap_b32 v52, v54
    v_permlane32_swap_b32 v53, v55
    v_pk_add_f32 v[52:53], v[52:53], v[54:55]
    s_nop 1
    v_permlane16_swap_b32 v52, v53
    v_add_f32 v52, v52, v53
    s_nop 1
    v_add_f32_dpp v52, v52, v52 row_ror:8 row_mask:0xf bank_mask:0xf
    s_mov_b64 exec, s[38:39]
    v_bfi_b32 v52, s35, v8, v52
    s_cmp_lg_u32 s49, 0
    s_cbranch_scc0 L_ds_48
    global_store_dword v31, v52, s[24:25]
    v_add_u32 v31, 8192, v31
    global_store_dword v31, v52, s[24:25]
L_ds_49:
    s_mov_b64 exec, -1
    s_cmp_ge_u32 s3, 3
    s_cbranch_scc1 L_fin
    s_cmp_ge_u32 s47, 20
    s_cbranch_scc1 L_fin
    v_add_u32 v12, 20480, v11
    v_add_u32 v13, 40960, v11
    s_mov_b64 s[52:53], exec
    s_mov_b64 s[54:55], exec
    s_mov_b64 s[62:63], exec
L_r1poll:
    s_mov_b64 exec, s[52:53]
    global_load_dwordx4 v[44:47], v14, s[24:25] sc1
    s_mov_b64 exec, s[54:55]
    global_load_dwordx4 v[48:51], v25, s[24:25] sc1
    s_mov_b32 s60, 0
    s_waitcnt vmcnt(0)
    s_mov_b64 exec, s[52:53]
    s_cbranch_execz L_sk_50
    v_xor_b32 v44, s34, v44
    v_xor_b32 v45, s34, v45
    v_xor_b32 v46, s34, v46
    v_xor_b32 v47, s34, v47
    v_or3_b32 v16, v44, v45, v46
    v_or_b32 v16, v16, v47
    v_and_b32 v16, s35, v16
    v_cmpx_ne_u32 vcc, 0, v16
    s_mov_b64 s[52:53], exec
    s_cbranch_execz L_sk_50
    s_bitset1_b32 s60, 0
L_sk_50:
    s_mov_b64 exec, s[54:55]
    s_cbranch_execz L_sk_51
    v_xor_b32 v48, s34, v48
    v_xor_b32 v49, s34, v49
    v_xor_b32 v50, s34, v50
    v_xor_b32 v51, s34, v51
    v_or3_b32 v16, v48, v49, v50
    v_or_b32 v16, v16, v51
    v_and_b32 v16, s35, v16
    v_cmpx_ne_u32 vcc, 0, v16
    s_mov_b64 s[54:55], exec
    s_cbranch_execz L_sk_51
    s_bitset1_b32 s60, 1
L_sk_51:
    s_cmp_lg_u32 s60, 0
    s_cbranch_scc1 L_r1poll_more
L_r1poll_ok:
    s_mov_b64 exec, s[62:63]
    s_cmp_lg_u32 s47, 0
    s_cbranch_scc1 L_noep
    v_mov_b32 v9, 0
    v_mov_b32 v10, s33
    s_mov_b64 exec, 1
    global_store_dword v9, v10, s[24:25] sc1
    s_mov_b64 exec, -1
L_noep:
    v_pk_add_f32 v[44:45], v[44:45], v[48:49]
    v_pk_add_f32 v[46:47], v[46:47], v[50:51]
    s_nop 1
    v_permlane32_swap_b32 v44, v46
    v_permlane32_swap_b32 v45, v47
    v_pk_add_f32 v[44:45], v[44:45], v[46:47]
    s_nop 1
    v_permlane16_swap_b32 v44, v45
    v_add_f32 v44, v44, v45
    s_nop 1
    v_add_f32_dpp v44, v44, v44 row_ror:8 row_mask:0xf bank_mask:0xf
    v_cvt_pk_bf16_f32 v16, v44, v44
    v_and_b32 v16, 0xffff0000, v16
    v_add_f32 v24, v16, v24
    v_cvt_pk_bf16_f32 v24, v24, v24
    v_and_b32 v24, 0xffff0000, v24
    global_load_dwordx4 v[100:103], v11, s[24:25] sc1
    global_load_dwordx4 v[104:107], v12, s[24:25] sc1
    global_load_dwordx4 v[108:111], v13, s[24:25] sc1
    s_sleep 2
    global_load_dwordx4 v[112:115], v11, s[24:25] sc1
    global_load_dwordx4 v[116:119], v12, s[24:25] sc1
    global_load_dwordx4 v[120:123], v13, s[24:25] sc1
L_r2poll:
    s_waitcnt vmcnt(3)
    v_xor_b32 v44, s34, v100
    v_xor_b32 v45, s34, v101
    v_xor_b32 v46, s34, v102
    v_xor_b32 v47, s34, v103
    v_xor_b32 v48, s34, v104
    v_xor_b32 v49, s34, v105
    v_xor_b32 v50, s34, v106
    v_xor_b32 v51, s34, v107
    v_xor_b32 v52, s34, v108
    v_xor_b32 v53, s34, v109
    v_xor_b32 v54, s34, v110
    v_xor_b32 v55, s34, v111
    v_or3_b32 v16, v44, v45, v46
    v_or3_b32 v16, v16, v47, v48
    v_or3_b32 v16, v16, v49, v50
    v_or3_b32 v16, v16, v51, v52
    v_or3_b32 v16, v16, v53, v54
    v_or_b32 v16, v16, v55
    v_and_b32 v16, s35, v16
    v_cmpx_ne_u32 vcc, 0, v16
    s_cbranch_execz L_r2poll_out
    global_load_dwordx4 v[100:103], v11, s[24:25] sc1
    global_load_dwordx4 v[104:107], v12, s[24:25] sc1
    global_load_dwordx4 v[108:111], v13, s[24:25] sc1
    s_waitcnt vmcnt(3)
    v_xor_b32 v44, s34, v112
    v_xor_b32 v45, s34, v113
    v_xor_b32 v46, s34, v114
    v_xor_b32 v47, s34, v115
    v_xor_b32 v48, s34, v116
    v_xor_b32 v49, s34, v117
    v_xor_b32 v50, s34, v118
    v_xor_b32 v51, s34, v119
    v_xor_b32 v52, s34, v120
    v_xor_b32 v53, s34, v121
    v_xor_b32 v54, s34, v122
    v_xor_b32 v55, s34, v123
    v_or3_b32 v16, v44, v45, v46
    v_or3_b32 v16, v16, v47, v48
    v_or3_b32 v16, v16, v49, v50
    v_or3_b32 v16, v16, v51, v52
    v_or3_b32 v16, v16, v53, v54
    v_or_b32 v16, v16, v55
    v_and_b32 v16, s35, v16
    v_cmpx_ne_u32 vcc, 0, v16
    s_cbranch_execz L_r2poll_out
    global_load_dwordx4 v[112:115], v11, s[24:25] sc1
    global_load_dwordx4 v[116:119], v12, s[24:25] sc1
    global_load_dwordx4 v[120:123], v13, s[24:25] sc1
    s_sub_u32 s100, s100, 1
    s_cbranch_scc0 L_r2poll
L_r2poll_out:
    s_mov_b64 exec, -1
    v_pk_add_f32 v[44:45], v[44:45], v[48:49]
    v_pk_add_f32 v[46:47], v[46:47], v[50:51]
    v_pk_add_f32 v[44:45], v[44:45], v[52:53]
    v_pk_add_f32 v[46:47], v[46:47], v[54:55]
    s_nop 1
    v_permlane32_swap_b32 v44, v46
    v_permlane32_swap_b32 v45, v47
    v_pk_add_f32 v[44:45], v[44:45], v[46:47]
    s_nop 1
    v_permlane16_swap_b32 v44, v45
    v_add_f32 v44, v44, v45
    s_nop 1
    v_add_f32_dpp v44, v44, v44 row_ror:8 row_mask:0xf bank_mask:0xf
    v_cvt_pk_bf16_f32 v16, v44, v44
    v_and_b32 v16, 0xffff0000, v16
    v_add_f32 v16, v16, v24
    s_mov_b64 exec, s[38:39]
    v_cvt_pk_bf16_f32 v16, v16, v16
    global_store_short v15, v16, s[20:21]
L_fin:
L_end:
    s_endpgm
L_score:
    ds_read_b128 v[108:111], v3 offset:21504
    ds_read_b128 v[112:115], v3 offset:21632
    ds_read_b128 v[116:119], v3 offset:21760
    s_mov_b32 s43, 1
    s_waitcnt lgkmcnt(0)
    v_dot2_f32_bf16 v16, v44, v108, 0
    v_dot2_f32_bf16 v18, v56, v108, 0
    v_dot2_f32_bf16 v17, v45, v109, 0
    v_dot2_f32_bf16 v19, v57, v109, 0
    v_dot2_f32_bf16 v16, v46, v110, v16
    v_dot2_f32_bf16 v18, v58, v110, v18
    v_dot2_f32_bf16 v17, v47, v111, v17
    v_dot2_f32_bf16 v19, v59, v111, v19
    v_dot2_f32_bf16 v16, v48, v112, v16
    v_dot2_f32_bf16 v18, v60, v112, v18
    v_dot2_f32_bf16 v17, v49, v113, v17
    v_dot2_f32_bf16 v19, v61, v113, v19
    v_dot2_f32_bf16 v16, v50, v114, v16
    v_dot2_f32_bf16 v18, v62, v114, v18
    v_dot2_f32_bf16 v17, v51, v115, v17
    v_dot2_f32_bf16 v19, v63, v115, v19
    v_dot2_f32_bf16 v16, v52, v116, v16
    v_dot2_f32_bf16 v18, v64, v116, v18
    v_dot2_f32_bf16 v17, v53, v117, v17
    v_dot2_f32_bf16 v19, v65, v117, v19
    v_dot2_f32_bf16 v16, v54, v118, v16
    v_dot2_f32_bf16 v18, v66, v118, v18
    v_dot2_f32_bf16 v17, v55, v119, v17
    v_dot2_f32_bf16 v19, v67, v119, v19
    s_lshl_b32 s28, s3, 2
    v_mov_b32 v10, s28
    s_nop 0
    v_add_f32 v16, v16, v17
    v_add_f32 v17, v18, v19
    s_nop 0
    v_add_f32_dpp v16, v16, v16 quad_perm:[1,0,3,2] row_mask:0xf bank_mask:0xf
    v_add_f32_dpp v17, v17, v17 quad_perm:[1,0,3,2] row_mask:0xf bank_mask:0xf
    s_nop 0
    v_add_f32_dpp v16, v16, v16 quad_perm:[2,3,0,1] row_mask:0xf bank_mask:0xf
    v_add_f32_dpp v17, v17, v17 quad_perm:[2,3,0,1] row_mask:0xf bank_mask:0xf
    s_nop 0
    v_add_f32_dpp v16, v16, v16 row_half_mirror row_mask:0xf bank_mask:0xf
    v_add_f32_dpp v17, v17, v17 row_half_mirror row_mask:0xf bank_mask:0xf
    v_cvt_pk_bf16_f32 v18, v16, v17
    v_lshlrev_b32 v16, 16, v18
    v_and_b32 v17, 0xffff0000, v18
    v_mul_f32 v16, 0x3d93cd3a, v16
    v_mul_f32 v17, 0x3d93cd3a, v17
    v_cvt_pk_bf16_f32 v18, v16, v17
    v_lshlrev_b32 v16, 16, v18
    v_and_b32 v17, 0xffff0000, v18
    v_max_f32 v9, v16, v17
    s_nop 1
    v_max_f32_dpp v9, v9, v9 row_ror:8 row_mask:0xf bank_mask:0xf
    v_mov_b32 v18, v9
    s_nop 1
    v_permlane16_swap_b32 v9, v18
    v_max_f32 v9, v9, v18
    v_mov_b32 v18, v9
    s_nop 1
    v_permlane32_swap_b32 v9, v18
    v_max_f32 v9, v9, v18
    ds_write_b32 v10, v9 offset:21888
    s_waitcnt lgkmcnt(0)
    s_setpc_b64 s[50:51]
L_meas:
    s_and_b32 s28, s101, 7
    s_lshl_b32 s28, s28, 14
    s_lshr_b32 s29, s101, 3
    s_lshl_b32 s29, s29, 7
    s_add_u32 s28, s28, s29
    s_add_u32 s28, s28, 658432
    s_add_u32 s30, s24, s28
    s_addc_u32 s31, s25, 0
    s_mov_b32 s60, 1
    s_mov_b32 s61, 0
    s_load_dword s52, s[30:31], 0 glc
    s_load_dword s53, s[30:31], 8192 glc
    s_load_dword s54, s[30:31], 4096 glc
    s_load_dword s55, s[30:31], 12288 glc
    s_load_dword s56, s[30:31], 512 glc
    s_load_dword s57, s[30:31], 8704 glc
    s_load_dword s58, s[30:31], 4608 glc
    s_load_dword s59, s[30:31], 12800 glc
    s_waitcnt lgkmcnt(0)
L_meas1:
    s_not_b32 s36, s52
    s_not_b32 s37, s53
    s_not_b32 s38, s54
    s_not_b32 s39, s55
    s_not_b32 s40, s56
    s_not_b32 s41, s57
    s_not_b32 s42, s58
    s_not_b32 s43, s59
    s_load_dword s36, s[30:31], 0 glc
    s_load_dword s37, s[30:31], 8192 glc
    s_load_dword s38, s[30:31], 4096 glc
    s_load_dword s39, s[30:31], 12288 glc
    s_load_dword s40, s[30:31], 512 glc
    s_load_dword s41, s[30:31], 8704 glc
    s_load_dword s42, s[30:31], 4608 glc
    s_load_dword s43, s[30:31], 12800 glc
    s_waitcnt lgkmcnt(4)
    s_cmp_eq_u32 s36, s52
    s_subb_u32 s61, s61, 0
    s_cmp_eq_u32 s37, s53
    s_addc_u32 s61, s61, 0
    s_cmp_eq_u32 s38, s54
    s_subb_u32 s61, s61, 0
    s_cmp_eq_u32 s39, s55
    s_addc_u32 s61, s61, 0
    s_cmp_eq_u32 s40, s56
    s_subb_u32 s61, s61, 0
    s_cmp_eq_u32 s41, s57
    s_addc_u32 s61, s61, 0
    s_cmp_eq_u32 s42, s58
    s_subb_u32 s61, s61, 0
    s_cmp_eq_u32 s43, s59
    s_addc_u32 s61, s61, 0
    s_waitcnt lgkmcnt(0)
    s_not_b32 s36, s52
    s_not_b32 s37, s53
    s_not_b32 s38, s54
    s_not_b32 s39, s55
    s_not_b32 s40, s56
    s_not_b32 s41, s57
    s_not_b32 s42, s58
    s_not_b32 s43, s59
    s_load_dword s37, s[30:31], 8192 glc
    s_load_dword s36, s[30:31], 0 glc
    s_load_dword s39, s[30:31], 12288 glc
    s_load_dword s38, s[30:31], 4096 glc
    s_load_dword s41, s[30:31], 8704 glc
    s_load_dword s40, s[30:31], 512 glc
    s_load_dword s43, s[30:31], 12800 glc
    s_load_dword s42, s[30:31], 4608 glc
    s_waitcnt lgkmcnt(4)
    s_cmp_eq_u32 s36, s52
    s_subb_u32 s61, s61, 0
    s_cmp_eq_u32 s37, s53
    s_addc_u32 s61, s61, 0
    s_cmp_eq_u32 s38, s54
    s_subb_u32 s61, s61, 0
    s_cmp_eq_u32 s39, s55
    s_addc_u32 s61, s61, 0
    s_cmp_eq_u32 s40, s56
    s_subb_u32 s61, s61, 0
    s_cmp_eq_u32 s41, s57
    s_addc_u32 s61, s61, 0
    s_cmp_eq_u32 s42, s58
    s_subb_u32 s61, s61, 0
    s_cmp_eq_u32 s43, s59
    s_addc_u32 s61, s61, 0
    s_waitcnt lgkmcnt(0)
    s_sub_u32 s60, s60, 1
    s_cmp_lg_u32 s60, 0
    s_cbranch_scc1 L_meas1
    s_cmp_gt_i32 s61, 0
    s_cselect_b32 s29, 0x4000, 0
    s_cmp_lt_i32 s61, 0
    s_cselect_b32 s29, 0x8000, s29
    s_setpc_b64 s[50:51]
L_fxcc:
    s_waitcnt lgkmcnt(0)
    s_add_u32 s33, s34, 1
    s_and_b32 s34, s33, s35
    v_mov_b32 v8, s34
    s_getreg_b32 s22, hwreg(HW_REG_XCC_ID, 0, 4)
    s_lshl_b32 s22, s22, 10
    s_or_b32 s22, s22, s34
    s_lshl_b32 s28, s101, 7
    s_add_u32 s28, s28, 917504
    s_or_b32 s29, s29, s22
    v_mov_b32 v12, s28
    v_mov_b32 v16, s29
    v_mov_b32 v17, s29
    s_mov_b64 exec, 1
    global_store_dwordx2 v12, v[16:17], s[24:25] sc1
    s_mov_b64 exec, -1
    s_setpc_b64 s[50:51]
L_fxchk:
    v_lshlrev_b32 v12, 7, v1
    v_add_u32 v12, 917504, v12
    s_mov_b64 exec, 0xffffffff
L_fxpoll:
    global_load_dwordx2 v[16:17], v12, s[24:25] sc1
    s_waitcnt vmcnt(0)
    v_xor_b32 v17, v16, v17
    v_xor_b32 v18, s34, v16
    v_and_or_b32 v17, v18, s35, v17
    v_cmp_ne_u32 vcc, 0, v17
    s_cbranch_vccnz L_fxpoll_retry
L_fxpoll_ok:
    v_and_b32 v17, 0x4000, v16
    v_cmp_ne_u32 vcc, 0, v17
    v_and_b32 v17, 0x8000, v16
    s_bcnt1_i32_b32 s31, vcc_lo
    v_cmp_ne_u32 vcc, 0, v17
    v_and_b32 v16, 0x3fff, v16
    s_bcnt1_i32_b32 s30, vcc_lo
    s_cmp_gt_u32 s31, s30
    s_cselect_b32 s31, 8192, 0
    v_cmp_ne_u32 vcc, s22, v16
    s_mov_b64 exec, -1
    s_cmp_eq_u32 vcc_lo, 0
    s_cselect_b32 s32, 1, 0
    v_mov_b32 v16, s32
    v_mov_b32 v17, s31
    v_mov_b32 v9, 93696
    ds_write_b64 v9, v[16:17]
    s_waitcnt lgkmcnt(0)
    s_setpc_b64 s[50:51]
L_qwait_retry:
    s_sleep 1
    s_sub_u32 s100, s100, 1
    s_cbranch_scc0 L_qwait
    s_branch L_qwait_ok
L_ws_29_retry:
    s_sleep 2
    s_sub_u32 s100, s100, 1
    s_cbranch_scc0 L_ws_29
    s_branch L_ws_29_ok
L_xpoll_retry:
    s_sub_u32 s100, s100, 1
    s_cbranch_scc0 L_xpoll
    s_branch L_xpoll_ok
L_ws_32_retry:
    s_sleep 2
    s_sub_u32 s100, s100, 1
    s_cbranch_scc0 L_ws_32
    s_branch L_ws_32_ok
L_fxpoll_retry:
    s_sub_u32 s100, s100, 1
    s_cbranch_scc0 L_fxpoll
    s_branch L_fxpoll_ok
L_qpoll_more:
    s_mov_b64 exec, s[62:63]
    s_add_u32 s20, s20, 1
    s_cmp_lg_u32 s20, 2
    s_cbranch_scc1 L_qr1
    s_mov_b64 exec, -1
    global_store_dword v10, v161, s[24:25] sc1
    s_mov_b64 exec, s[62:63]
L_qr1:
    s_sub_u32 s100, s100, 1
    s_cbranch_scc1 L_qpoll_ok
    s_branch L_qpoll
L_op_s:
    s_mov_b64 s[54:55], exec
    global_load_dwordx4 v[48:51], v12, s[24:25] sc1
    s_sub_u32 s100, s100, 1
    s_cbranch_scc0 L_op_a
    s_branch L_op_w
L_hpoll_more:
    s_sub_u32 s100, s100, 1
    s_cbranch_scc1 L_hpoll_ok
    s_cmp_eq_u32 s60, 1
    s_cbranch_scc1 L_hpoll_t0
    s_cmp_eq_u32 s60, 2
    s_cbranch_scc1 L_hpoll_t1
    s_cmp_eq_u32 s60, 4
    s_cbranch_scc1 L_hpoll_t2
    s_cmp_eq_u32 s60, 8
    s_cbranch_scc1 L_hpoll_t3
    s_branch L_hpoll
L_hpoll_t0:
    s_mov_b64 exec, s[52:53]
L_hpoll_l0:
    global_load_dwordx4 v[64:67], v13, s[24:25] sc1
    s_sub_u32 s100, s100, 1
    s_cbranch_scc1 L_hpoll_l0_out
    s_waitcnt vmcnt(0)
    v_xor_b32 v64, s34, v64
    v_xor_b32 v65, s34, v65
    v_xor_b32 v66, s34, v66
    v_xor_b32 v67, s34, v67
    v_or3_b32 v16, v64, v65, v66
    v_or_b32 v16, v16, v67
    v_and_b32 v16, s35, v16
    v_cmpx_ne_u32 vcc, 0, v16
    s_cbranch_execnz L_hpoll_l0
L_hpoll_l0_out:
    s_branch L_hpoll_ok
L_hpoll_t1:
    s_mov_b64 exec, s[54:55]
L_hpoll_l1:
    global_load_dwordx4 v[68:71], v14, s[24:25] sc1
    s_sub_u32 s100, s100, 1
    s_cbranch_scc1 L_hpoll_l1_out
    s_waitcnt vmcnt(0)
    v_xor_b32 v68, s34, v68
    v_xor_b32 v69, s34, v69
    v_xor_b32 v70, s34, v70
    v_xor_b32 v71, s34, v71
    v_or3_b32 v16, v68, v69, v70
    v_or_b32 v16, v16, v71
    v_and_b32 v16, s35, v16
    v_cmpx_ne_u32 vcc, 0, v16
    s_cbranch_execnz L_hpoll_l1
L_hpoll_l1_out:
    s_branch L_hpoll_ok
L_hpoll_t2:
    s_mov_b64 exec, s[56:57]
L_hpoll_l2:
    global_load_dwordx4 v[72:75], v15, s[24:25] sc1
    s_sub_u32 s100, s100, 1
    s_cbranch_scc1 L_hpoll_l2_out
    s_waitcnt vmcnt(0)
    v_xor_b32 v72, s34, v72
    v_xor_b32 v73, s34, v73
    v_xor_b32 v74, s34, v74
    v_xor_b32 v75, s34, v75
    v_or3_b32 v16, v72, v73, v74
    v_or_b32 v16, v16, v75
    v_and_b32 v16, s35, v16
    v_cmpx_ne_u32 vcc, 0, v16
    s_cbranch_execnz L_hpoll_l2
L_hpoll_l2_out:
    s_branch L_hpoll_ok
L_hpoll_t3:
    s_mov_b64 exec, s[58:59]
L_hpoll_l3:
    global_load_dwordx4 v[76:79], v25, s[24:25] sc1
    s_sub_u32 s100, s100, 1
    s_cbranch_scc1 L_hpoll_l3_out
    s_waitcnt vmcnt(0)
    v_xor_b32 v76, s34, v76
    v_xor_b32 v77, s34, v77
    v_xor_b32 v78, s34, v78
    v_xor_b32 v79, s34, v79
    v_or3_b32 v16, v76, v77, v78
    v_or_b32 v16, v16, v79
    v_and_b32 v16, s35, v16
    v_cmpx_ne_u32 vcc, 0, v16
    s_cbranch_execnz L_hpoll_l3
L_hpoll_l3_out:
    s_branch L_hpoll_ok
L_xop_s:
    s_mov_b64 s[54:55], exec
    s_sleep 2
    global_load_dwordx4 v[48:51], v12, s[24:25] sc1
    s_sub_u32 s100, s100, 1
    s_cbranch_scc0 L_xop_a
    s_branch L_xop_w
L_r1poll_more:
    s_sub_u32 s100, s100, 1
    s_cbranch_scc1 L_r1poll_ok
    s_cmp_eq_u32 s60, 1
    s_cbranch_scc1 L_r1poll_t0
    s_cmp_eq_u32 s60, 2
    s_cbranch_scc1 L_r1poll_t1
    s_sleep 4
    s_branch L_r1poll
L_r1poll_t0:
    s_mov_b64 exec, s[52:53]
L_r1poll_l0:
    global_load_dwordx4 v[44:47], v14, s[24:25] sc1
    s_sub_u32 s100, s100, 1
    s_cbranch_scc1 L_r1poll_l0_out
    s_waitcnt vmcnt(0)
    v_xor_b32 v44, s34, v44
    v_xor_b32 v45, s34, v45
    v_xor_b32 v46, s34, v46
    v_xor_b32 v47, s34, v47
    v_or3_b32 v16, v44, v45, v46
    v_or_b32 v16, v16, v47
    v_and_b32 v16, s35, v16
    v_cmpx_ne_u32 vcc, 0, v16
    s_cbranch_execnz L_r1poll_l0
L_r1poll_l0_out:
    s_branch L_r1poll_ok
L_r1poll_t1:
    s_mov_b64 exec, s[54:55]
L_r1poll_l1:
    global_load_dwordx4 v[48:51], v25, s[24:25] sc1
    s_sub_u32 s100, s100, 1
    s_cbranch_scc1 L_r1poll_l1_out
    s_waitcnt vmcnt(0)
    v_xor_b32 v48, s34, v48
    v_xor_b32 v49, s34, v49
    v_xor_b32 v50, s34, v50
    v_xor_b32 v51, s34, v51
    v_or3_b32 v16, v48, v49, v50
    v_or_b32 v16, v16, v51
    v_and_b32 v16, s35, v16
    v_cmpx_ne_u32 vcc, 0, v16
    s_cbranch_execnz L_r1poll_l1
L_r1poll_l1_out:
    s_branch L_r1poll_ok
L_ds_23:
    global_store_dword v25, v120, s[24:25] sc1
    s_cmp_lt_u32 s101, 28
    s_cbranch_scc1 L_ds_24
    v_add_u32 v25, 8192, v25
    global_store_dword v25, v120, s[24:25] sc1
    s_branch L_ds_24
L_ds_25:
    global_store_dword v10, v44, s[24:25] offset:0 sc1
    s_branch L_ds_26
L_ds_27:
    global_store_dword v10, v68, s[24:25] offset:256 sc1
    s_branch L_ds_28
L_ds_30:
    global_store_dword v10, v92, s[24:25] sc1
    s_branch L_ds_31
L_ds_40:
    global_store_dwordx4 v10, v[16:19], s[24:25] sc1
    s_cmp_lt_u32 s101, 28
    s_cbranch_scc1 L_ds_41
    v_add_u32 v10, 8192, v10
    global_store_dwordx4 v10, v[16:19], s[24:25] sc1
    s_branch L_ds_41
L_ds_46:
    global_store_dword v30, v64, s[24:25] sc1
    s_nop 0
    v_bfi_b32 v68, s35, v8, v68
    global_store_dword v30, v68, s[24:25] offset:256 sc1
    s_nop 1
    v_bfi_b32 v72, s35, v8, v72
    s_mov_b64 exec, 0xffffffff
    global_store_dword v30, v72, s[24:25] offset:512 sc1
    s_branch L_ds_47
L_ds_48:
    global_store_dword v31, v52, s[24:25] sc1
    v_add_u32 v31, 8192, v31
    global_store_dword v31, v52, s[24:25] sc1
    s_branch L_ds_49
.section .rodata,"a"
.p2align 6
.amdhsa_kernel sequential_preLN__sliding_block_cached__dense_activation_silu__decode_kernel
  .amdhsa_next_free_vgpr 168
  .amdhsa_next_free_sgpr 102
  .amdhsa_accum_offset 168
  .amdhsa_group_segment_fixed_size 0
  .amdhsa_kernarg_size 88
  .amdhsa_user_sgpr_count 2
  .amdhsa_user_sgpr_kernarg_segment_ptr 1
  .amdhsa_system_sgpr_workgroup_id_x 1
  .amdhsa_float_denorm_mode_32 3
.end_amdhsa_kernel
```
